```python
import torch

def _softmax(x, axis=-1):
    return torch.softmax(x, dim=axis)
def _gelu(x):
    return torch.nn.functional.gelu(x, approximate="tanh")
def _silu(x):
    return torch.nn.functional.silu(x)
def _sigmoid(x):
    return torch.sigmoid(x)
def _layernorm(x, axis=-1, eps=1e-5):
    m = x.mean(dim=axis, keepdim=True)
    v = x.var(dim=axis, keepdim=True, unbiased=False)
    return (x - m) / torch.sqrt(v + eps)
def _scatter_add(tgt, idx, src, axis=0):
    return tgt.clone().index_add_(axis, idx, src)
def _segment_sum(src, seg, n):
    out = torch.zeros((n,) + src.shape[1:], dtype=src.dtype)
    return out.index_add_(0, seg, src)
def _pad(x, pw):
    flat = tuple(v for pair in reversed(pw) for v in pair)
    return torch.nn.functional.pad(x, flat)

kernel_name = 'parallel_sum__sliding_block__glu_gated_glu__prompt'

def setup_inputs():

    _w = (lambda a: (lambda t: t.to(torch.bfloat16) if t.is_floating_point() else t)(torch.as_tensor(a)))
    def _A_setup():
        B, S, D = 1, 2048, 640
        return {
            "x": _w((lambda *s: torch.randn(*s, dtype=torch.bfloat16) * 0.05)(B, S, D)),
            "wqkv": _w((lambda *s: torch.randn(*s, dtype=torch.bfloat16) * 0.05)(D, 3 * D)),
            "wo": _w((lambda *s: torch.randn(*s, dtype=torch.bfloat16) * 0.05)(D, D)),
        }
    _A_in = _A_setup()

    def _B_setup():
        B, S, D, F = 1, 2048, 640, 1536
        return {
            "x": _w((lambda *s: torch.randn(*s, dtype=torch.bfloat16) * 0.05)(B, S, D)),
            "w_gate": _w((lambda *s: torch.randn(*s, dtype=torch.bfloat16) * 0.05)(D, F)),
            "w_up": _w((lambda *s: torch.randn(*s, dtype=torch.bfloat16) * 0.05)(D, F)),
            "w_down": _w((lambda *s: torch.randn(*s, dtype=torch.bfloat16) * 0.05)(F, D)),
        }
    _B_in = _B_setup()

    return {
        "A_x": _A_in["x"],
        "A_wqkv": _A_in["wqkv"],
        "A_wo": _A_in["wo"],
        "B_x": _B_in["x"],
        "B_w_gate": _B_in["w_gate"],
        "B_w_up": _B_in["w_up"],
        "B_w_down": _B_in["w_down"],
    }

def reference(A_x, A_wqkv, A_wo, B_x, B_w_gate, B_w_up, B_w_down):
    def _A_ref(x, wqkv, wo):
        B, S, D = x.shape
        H = 32; Dh = D // H; W = 256
        qkv = (lambda x, *d: x.permute(*d))((x @ wqkv).reshape(B, S, 3, H, Dh), 2, 0, 3, 1, 4)
        q, k, v = qkv[0], qkv[1], qkv[2]
        scores = torch.einsum("bhqd,bhkd->bhqk", q, k) * (Dh ** -0.5)
        idx = torch.arange(S)
        mask = (idx[:, None] - idx[None, :] >= 0) & (idx[:, None] - idx[None, :] < W)
        scores = torch.where(mask[None, None], scores, -1e9)
        p = _softmax(scores, axis=-1)
        o = torch.einsum("bhqk,bhkd->bhqd", p, v)
        return (lambda x, *d: x.permute(*d))(o, 0, 2, 1, 3).reshape(B, S, D) @ wo

    def _B_ref(x, w_gate, w_up, w_down):
        g = torch.einsum("bsd,df->bsf", x, w_gate)
        u = torch.einsum("bsd,df->bsf", x, w_up)
        h = _sigmoid(g) * u
        return torch.einsum("bsf,fd->bsd", h, w_down)

    x = A_x
    xn = _layernorm(x, axis=-1)
    return x + _A_ref(xn, A_wqkv, A_wo) + _B_ref(xn, B_w_gate, B_w_up, B_w_down)
```

```asm
; @launch grid=(256,1,1) block=(512,1,1) lds=163840
  .amdgcn_target "amdgcn-amd-amdhsa--gfx950"
  .text
  .globl parallel_sum__sliding_block__glu_gated_glu__prompt_kernel
  .p2align 8
  .type parallel_sum__sliding_block__glu_gated_glu__prompt_kernel,@function
parallel_sum__sliding_block__glu_gated_glu__prompt_kernel:
  s_cmp_ge_u32 s2, 256
  s_cbranch_scc1 L_end
  s_load_dwordx16 s[4:19], s[0:1], 0
  s_load_dwordx4 s[20:23], s[0:1], 64
  v_lshrrev_b32 v1, 6, v0
  v_and_b32 v0, 63, v0
  v_readfirstlane_b32 s3, v1
  s_and_b32 s26, s2, 7
  s_lshr_b32 s27, s2, 3
  s_and_b32 s48, s26, 1
  s_lshl_b32 s48, s48, 3
  s_and_b32 s49, s27, 7
  s_add_u32 s24, s48, s49
  s_lshr_b32 s48, s26, 1
  s_lshl_b32 s25, s48, 1
  s_lshr_b32 s49, s27, 3
  s_and_b32 s48, s49, 1
  s_add_u32 s25, s25, s48
  s_lshr_b32 s49, s49, 1
  s_lshl_b32 s49, s49, 3
  s_add_u32 s25, s25, s49
  s_bfe_u32 s82, s24, 0x10002
  s_mul_i32 s49, s24, 163840
  s_mov_b32 s46, 163840
  s_mov_b32 s47, 0x20000
  s_mov_b32 s35, 0x20000
  s_mov_b32 s39, 0x20000
  s_mov_b32 s43, 0x20000
  s_and_b32 s52, s25, 7
  s_mul_i32 s48, s52, 3
  s_add_u32 s48, s48, 8
  s_min_u32 s83, s48, 27
  s_lshl_b32 s48, s83, 7
  s_add_u32 s55, s48, 256
  s_lshl_b32 s53, s52, 8
  s_lshl_b32 s54, s52, 7
  s_add_u32 s59, s54, 2048
  s_add_u32 s60, s53, 128
  s_cmp_ge_u32 s25, 8
  s_cselect_b32 s56, s48, s53
  s_cselect_b32 s57, s59, s53
  s_cselect_b32 s61, s59, s60
  s_cselect_b32 s58, s55, s54
  s_movk_i32 s48, 3072
  s_cselect_b32 s51, 3840, s48
  s_mul_i32 s59, s51, 640
  s_sub_u32 s34, s59, s56
  s_sub_u32 s38, 1966080, s57
  s_sub_u32 s62, 1966080, s61
  s_sub_u32 s42, 2457600, s58
  s_cmp_eq_u32 s25, 15
  s_cselect_b32 s34, 0, s34
  s_waitcnt lgkmcnt(0)
  s_cmp_ge_u32 s25, 8
  s_cselect_b32 s32, s6, s12
  s_cselect_b32 s33, s7, s13
  s_cselect_b32 s36, s12, s14
  s_cselect_b32 s37, s13, s15
  s_add_u32 s44, s4, s49
  s_addc_u32 s45, s5, 0
  s_and_b32 s45, s45, 0xffff
  s_add_u32 s32, s32, s56
  s_addc_u32 s33, s33, 0
  s_and_b32 s33, s33, 0xffff
  s_add_u32 s36, s36, s57
  s_addc_u32 s37, s37, 0
  s_and_b32 s37, s37, 0xffff
  s_add_u32 s40, s6, s58
  s_addc_u32 s41, s7, 0
  s_and_b32 s41, s41, 0xffff
  s_add_u32 s12, s14, s61
  s_addc_u32 s13, s15, 0
  s_and_b32 s13, s13, 0xffff
  s_mov_b32 s14, s62
  s_mov_b32 s15, 0x20000
  s_mov_b32 s28, s22
  s_and_b32 s29, s23, 0xffff
  s_mov_b32 s30, 19742720
  s_mov_b32 s31, 0x20000
  s_cmp_lt_u32 s3, 4
  s_cbranch_scc1 L_main
  s_setprio 3
  s_sub_u32 s50, s3, 4
  v_lshrrev_b32 v40, 3, v0
  v_and_b32 v41, 7, v0
  v_lshrrev_b32 v42, 4, v0
  s_lshl_b32 s48, s50, 5
  v_add_u32 v43, s48, v40
  v_mul_u32_u24 v43, 1280, v43
  v_xor_b32 v44, v41, v42
  v_lshl_add_u32 v2, v44, 4, v43
  v_xor_b32 v44, 4, v44
  v_lshl_add_u32 v3, v44, 4, v43
  v_add_u32 v3, 9216, v3
  s_lshl_b32 s57, s50, 12
  s_and_b32 s63, s24, 3
  s_mul_i32 s48, s82, 5
  s_add_u32 s64, s63, s48
  s_lshr_b32 s48, s27, 3
  s_mul_i32 s48, s48, 5
  s_add_u32 s48, s48, 1
  s_lshr_b32 s48, s48, 1
  s_add_u32 s64, s64, s48
  s_lshr_b32 s48, s24, 3
  s_lshl_b32 s48, s48, 2
  s_add_u32 s64, s64, s48
  s_add_u32 s63, s63, s48
  s_cmp_ge_u32 s64, 10
  s_cselect_b32 s48, 10, 0
  s_sub_u32 s64, s64, s48
  s_cmp_ge_u32 s64, 10
  s_cselect_b32 s48, 10, 0
  s_sub_u32 s64, s64, s48
  s_lshl_b32 s59, s64, 7
  s_add_u32 m0, s57, 0
  s_add_u32 s65, s59, 0
  buffer_load_dwordx4 v2, s[44:47], s65 offen lds
  buffer_load_dwordx4 v3, s[44:47], s65 offen offset:1024 lds
  s_add_u32 m0, s57, 2048
  s_add_u32 s65, s59, 20480
  buffer_load_dwordx4 v2, s[44:47], s65 offen lds
  buffer_load_dwordx4 v3, s[44:47], s65 offen offset:1024 lds
  s_add_u32 s59, s59, 128
  s_cmp_eq_u32 s59, 1280
  s_cselect_b32 s59, 0, s59
  s_lshl_b32 s48, s50, 3
  v_add_u32 v43, s48, v40
  v_and_b32 v44, 1, v42
  v_lshlrev_b32 v44, 2, v44
  v_xor_b32 v44, v41, v44
  s_and_b32 s48, s50, 1
  s_lshl_b32 s48, s48, 1
  v_xor_b32 v44, s48, v44
  v_lshlrev_b32 v44, 4, v44
  v_mad_u32_u24 v4, v43, s51, v44
  v_mul_u32_u24 v45, 3840, v43
  v_add_u32 v5, v45, v44
  v_mul_u32_u24 v45, 3072, v43
  v_add_u32 v7, v45, v44
  s_lshl_b32 s52, s51, 5
  s_lshl_b32 s48, s64, 1
  s_mul_i32 s53, s48, s52
  s_mul_i32 s54, s48, 122880
  s_mul_i32 s56, s48, 98304
  s_lshl_b32 s55, s50, 10
  s_add_u32 m0, s55, 32768
  s_nop 0
  buffer_load_dwordx4 v4, s[32:35], s53 offen lds
  s_add_u32 m0, s55, 49024
  s_nop 0
  buffer_load_dwordx4 v4, s[32:35], s53 offen offset:128 lds
  s_add_u32 m0, s55, 65536
  s_add_u32 s53, s53, s52
  buffer_load_dwordx4 v7, s[36:39], s56 offen lds
  s_add_u32 m0, s55, 81920
  s_nop 0
  buffer_load_dwordx4 v7, s[12:15], s56 offen lds
  s_add_u32 m0, s55, 98304
  s_add_u32 s56, s56, 98304
  buffer_load_dwordx4 v5, s[40:43], s54 offen lds
  s_add_u32 s54, s54, 122880
  s_mul_i32 s60, s63, 3
  s_add_u32 s60, s60, s50
  s_cmp_lt_u32 s60, 20
  s_cselect_b32 s61, 1, 0
  s_cmp_lt_u32 s50, 3
  s_cselect_b32 s61, s61, 0
  s_cmp_eq_u32 s61, 1
  s_cselect_b32 s60, s60, 0
  v_bfe_u32 v40, v0, 2, 2
  v_lshrrev_b32 v41, 4, v0
  v_lshl_add_u32 v6, v41, 3, v40
  v_lshlrev_b32 v6, 7, v6
  v_and_b32 v42, 2, v40
  v_and_b32 v41, 1, v41
  v_or_b32 v42, v42, v41
  v_lshl_add_u32 v6, v42, 5, v6
  v_and_b32 v42, 3, v0
  v_lshl_add_u32 v6, v42, 3, v6
  v_add_u32 v6, 32768, v6
  s_and_b32 s48, s60, 3
  s_lshl_b32 s48, s48, 5
  v_xor_b32 v6, s48, v6
  s_lshr_b32 s48, s60, 2
  s_lshl_b32 s48, s48, 14
  v_add_u32 v6, s48, v6
  v_mov_b32 v8, 0
  v_mov_b32 v12, 0x3f803f80
  v_mov_b32 v9, 0
  v_mov_b32 v13, 0x3f803f80
  v_mov_b32 v10, 0
  v_mov_b32 v14, 0x3f803f80
  v_mov_b32 v11, 0
  v_mov_b32 v15, 0x3f803f80
  s_lshl_b32 s62, s50, 5
  s_lshl_b32 s70, s50, 8
  s_add_u32 s70, s70, s2
  s_lshr_b32 s71, s70, 1
  s_and_b32 s72, s70, 1
  s_lshl_b32 s73, s71, 3
  s_mov_b32 s74, 4
  s_mov_b32 s76, s16
  s_mov_b32 s77, s17
  s_mov_b32 s78, 1966080
  s_cmp_lt_u32 s71, 192
  s_cbranch_scc1 L_w2set_1
  s_mov_b32 s76, s8
  s_mov_b32 s77, s9
  s_mov_b32 s78, 819200
  s_sub_u32 s48, s71, 192
  s_lshr_b32 s49, s48, 1
  s_mul_i32 s49, s49, 20
  s_and_b32 s48, s48, 1
  s_lshl_b32 s48, s48, 2
  s_add_u32 s73, s49, s48
  s_mov_b32 s74, 8
  s_cmp_lt_u32 s71, 256
  s_cbranch_scc1 L_w2set_1
  s_sub_u32 s48, s71, 256
  s_mul_i32 s48, s48, 40
  s_add_u32 s73, s48, 16
  s_mov_b32 s74, 20
L_w2set_1:
  s_and_b32 s77, s77, 0xffff
  s_mov_b32 s79, 0x20000
  s_cmp_ge_u32 s70, 544
  s_cselect_b32 s78, 0, s78
  s_mul_i32 s80, s73, 1280
  s_mul_i32 s48, s72, 640
  s_add_u32 s80, s80, s48
  s_mul_i32 s81, s50, 5120
  s_add_u32 s81, s81, 114688
  s_mov_b32 s48, 107374183
  s_mul_i32 s49, s74, 1280
  v_add_u32 v44, 0, v0
  v_mul_hi_u32 v45, v44, s48
  v_mul_u32_u24 v46, 40, v45
  v_sub_u32 v46, v44, v46
  v_and_b32 v47, 3, v45
  v_mul_u32_u24 v47, 1280, v47
  v_lshrrev_b32 v45, 2, v45
  v_mul_lo_u32 v45, v45, s49
  v_add_u32 v45, v45, v47
  v_lshl_add_u32 v48, v46, 4, v45
  v_add_u32 v44, 64, v0
  v_mul_hi_u32 v45, v44, s48
  v_mul_u32_u24 v46, 40, v45
  v_sub_u32 v46, v44, v46
  v_and_b32 v47, 3, v45
  v_mul_u32_u24 v47, 1280, v47
  v_lshrrev_b32 v45, 2, v45
  v_mul_lo_u32 v45, v45, s49
  v_add_u32 v45, v45, v47
  v_lshl_add_u32 v49, v46, 4, v45
  v_add_u32 v44, 128, v0
  v_mul_hi_u32 v45, v44, s48
  v_mul_u32_u24 v46, 40, v45
  v_sub_u32 v46, v44, v46
  v_and_b32 v47, 3, v45
  v_mul_u32_u24 v47, 1280, v47
  v_lshrrev_b32 v45, 2, v45
  v_mul_lo_u32 v45, v45, s49
  v_add_u32 v45, v45, v47
  v_lshl_add_u32 v50, v46, 4, v45
  v_add_u32 v44, 192, v0
  v_mul_hi_u32 v45, v44, s48
  v_mul_u32_u24 v46, 40, v45
  v_sub_u32 v46, v44, v46
  v_and_b32 v47, 3, v45
  v_mul_u32_u24 v47, 1280, v47
  v_lshrrev_b32 v45, 2, v45
  v_mul_lo_u32 v45, v45, s49
  v_add_u32 v45, v45, v47
  v_lshl_add_u32 v51, v46, 4, v45
  v_add_u32 v44, 256, v0
  v_mul_hi_u32 v45, v44, s48
  v_mul_u32_u24 v46, 40, v45
  v_sub_u32 v46, v44, v46
  v_and_b32 v47, 3, v45
  v_mul_u32_u24 v47, 1280, v47
  v_lshrrev_b32 v45, 2, v45
  v_mul_lo_u32 v45, v45, s49
  v_add_u32 v45, v45, v47
  v_lshl_add_u32 v52, v46, 4, v45
  v_bfe_u32 v53, v0, 2, 2
  v_mul_u32_u24 v53, 640, v53
  v_lshrrev_b32 v45, 4, v0
  v_mul_u32_u24 v46, 160, v45
  v_add_u32 v53, v53, v46
  v_and_b32 v46, 3, v0
  v_mul_u32_u24 v46, 40, v46
  v_add_u32 v53, v53, v46
  v_add_u32 v53, s81, v53
  s_lshl_b32 s48, s72, 2
  v_add_u32 v45, s48, v45
  v_mul_u32_u24 v45, 348160, v45
  v_and_b32 v46, 15, v0
  v_lshl_add_u32 v54, v46, 4, v45
  s_lshr_b32 s48, s71, 2
  s_mul_i32 s48, s48, 5120
  s_and_b32 s49, s71, 3
  s_lshl_b32 s49, s49, 8
  s_add_u32 s48, s48, s49
  s_add_u32 s73, s48, 16777216
  s_cmp_ge_u32 s70, 544
  s_cselect_b32 s73, 1073741824, s73
  s_add_u32 s74, s73, 4096
  s_lshl_b32 s48, s25, 3
  s_lshl_b32 s49, s50, 1
  s_add_u32 s48, s48, s49
  v_lshrrev_b32 v55, 5, v0
  v_add_u32 v55, s48, v55
  v_mul_u32_u24 v55, 1280, v55
  v_and_b32 v45, 31, v0
  v_lshl_add_u32 v55, v45, 4, v55
  v_mov_b32 v56, 1073741824
  v_cmp_gt_u32 vcc, 16, v45
  s_nop 1
  v_cndmask_b32 v56, v56, v55, vcc
  s_add_u32 m0, s55, 36864
  s_nop 0
  buffer_load_dwordx4 v4, s[32:35], s53 offen lds
  s_add_u32 m0, s55, 53120
  s_nop 0
  buffer_load_dwordx4 v4, s[32:35], s53 offen offset:128 lds
  s_add_u32 m0, s55, 69632
  s_add_u32 s53, s53, s52
  buffer_load_dwordx4 v7, s[36:39], s56 offen lds
  s_add_u32 m0, s55, 86016
  s_nop 0
  buffer_load_dwordx4 v7, s[12:15], s56 offen lds
  s_add_u32 m0, s55, 102400
  s_add_u32 s56, s56, 98304
  buffer_load_dwordx4 v5, s[40:43], s54 offen lds
  s_add_u32 s54, s54, 122880
  s_cmp_eq_u32 s54, 2457600
  s_cselect_b32 s53, 0, s53
  s_cselect_b32 s54, 0, s54
  s_cselect_b32 s56, 0, s56
  s_waitcnt vmcnt(5)
  s_barrier
  ds_read_b64_tr_b16 v[16:17], v6 offset:0
  ds_read_b64_tr_b16 v[18:19], v6 offset:512
  s_add_u32 m0, s57, 16384
  s_add_u32 s65, s59, 0
  buffer_load_dwordx4 v2, s[44:47], s65 offen lds
  buffer_load_dwordx4 v3, s[44:47], s65 offen offset:1024 lds
  s_add_u32 m0, s57, 18432
  s_add_u32 s65, s59, 20480
  buffer_load_dwordx4 v2, s[44:47], s65 offen lds
  buffer_load_dwordx4 v3, s[44:47], s65 offen offset:1024 lds
  s_add_u32 s59, s59, 128
  s_cmp_eq_u32 s59, 1280
  s_cselect_b32 s59, 0, s59
  s_add_u32 m0, s55, 40960
  s_nop 0
  buffer_load_dwordx4 v4, s[32:35], s53 offen lds
  s_add_u32 m0, s55, 57216
  s_nop 0
  buffer_load_dwordx4 v4, s[32:35], s53 offen offset:128 lds
  s_add_u32 m0, s55, 73728
  s_add_u32 s53, s53, s52
  buffer_load_dwordx4 v7, s[36:39], s56 offen lds
  s_add_u32 m0, s55, 90112
  s_nop 0
  buffer_load_dwordx4 v7, s[12:15], s56 offen lds
  s_add_u32 m0, s55, 106496
  s_add_u32 s56, s56, 98304
  buffer_load_dwordx4 v5, s[40:43], s54 offen lds
  s_add_u32 s54, s54, 122880
  s_waitcnt lgkmcnt(0)
  v_mfma_f32_16x16x32_bf16 v[8:11], v[16:19], v[12:15], v[8:11]
  s_waitcnt vmcnt(9)
  s_barrier
  ds_read_b64_tr_b16 v[16:17], v6 offset:4096
  ds_read_b64_tr_b16 v[18:19], v6 offset:4608
  s_add_u32 m0, s55, 45056
  s_nop 0
  buffer_load_dwordx4 v4, s[32:35], s53 offen lds
  s_add_u32 m0, s55, 61312
  s_nop 0
  buffer_load_dwordx4 v4, s[32:35], s53 offen offset:128 lds
  s_add_u32 m0, s55, 77824
  s_add_u32 s53, s53, s52
  buffer_load_dwordx4 v7, s[36:39], s56 offen lds
  s_add_u32 m0, s55, 94208
  s_nop 0
  buffer_load_dwordx4 v7, s[12:15], s56 offen lds
  s_add_u32 m0, s55, 110592
  s_add_u32 s56, s56, 98304
  buffer_load_dwordx4 v5, s[40:43], s54 offen lds
  s_add_u32 s54, s54, 122880
  s_cmp_eq_u32 s54, 2457600
  s_cselect_b32 s53, 0, s53
  s_cselect_b32 s54, 0, s54
  s_cselect_b32 s56, 0, s56
  s_add_u32 m0, s55, 32768
  s_nop 0
  buffer_load_dwordx4 v4, s[32:35], s53 offen lds
  s_add_u32 m0, s55, 49024
  s_nop 0
  buffer_load_dwordx4 v4, s[32:35], s53 offen offset:128 lds
  s_add_u32 m0, s55, 65536
  s_add_u32 s53, s53, s52
  buffer_load_dwordx4 v7, s[36:39], s56 offen lds
  s_add_u32 m0, s55, 81920
  s_nop 0
  buffer_load_dwordx4 v7, s[12:15], s56 offen lds
  s_add_u32 m0, s55, 98304
  s_add_u32 s56, s56, 98304
  buffer_load_dwordx4 v5, s[40:43], s54 offen lds
  s_add_u32 s54, s54, 122880
  s_waitcnt lgkmcnt(0)
  v_mfma_f32_16x16x32_bf16 v[8:11], v[16:19], v[12:15], v[8:11]
  s_waitcnt vmcnt(10)
  s_barrier
  ds_read_b64_tr_b16 v[16:17], v6 offset:8192
  ds_read_b64_tr_b16 v[18:19], v6 offset:8704
  s_add_u32 m0, s57, 0
  s_add_u32 s65, s59, 0
  buffer_load_dwordx4 v2, s[44:47], s65 offen lds
  buffer_load_dwordx4 v3, s[44:47], s65 offen offset:1024 lds
  s_add_u32 m0, s57, 2048
  s_add_u32 s65, s59, 20480
  buffer_load_dwordx4 v2, s[44:47], s65 offen lds
  buffer_load_dwordx4 v3, s[44:47], s65 offen offset:1024 lds
  s_add_u32 s59, s59, 128
  s_cmp_eq_u32 s59, 1280
  s_cselect_b32 s59, 0, s59
  s_add_u32 m0, s55, 36864
  s_nop 0
  buffer_load_dwordx4 v4, s[32:35], s53 offen lds
  s_add_u32 m0, s55, 53120
  s_nop 0
  buffer_load_dwordx4 v4, s[32:35], s53 offen offset:128 lds
  s_add_u32 m0, s55, 69632
  s_add_u32 s53, s53, s52
  buffer_load_dwordx4 v7, s[36:39], s56 offen lds
  s_waitcnt lgkmcnt(0)
  v_mfma_f32_16x16x32_bf16 v[8:11], v[16:19], v[12:15], v[8:11]
  s_waitcnt vmcnt(12)
  s_barrier
  ds_read_b64_tr_b16 v[16:17], v6 offset:12288
  ds_read_b64_tr_b16 v[18:19], v6 offset:12800
  s_add_u32 m0, s55, 86016
  s_nop 0
  buffer_load_dwordx4 v7, s[12:15], s56 offen lds
  s_add_u32 m0, s55, 102400
  s_add_u32 s56, s56, 98304
  buffer_load_dwordx4 v5, s[40:43], s54 offen lds
  s_add_u32 s54, s54, 122880
  s_cmp_eq_u32 s54, 2457600
  s_cselect_b32 s53, 0, s53
  s_cselect_b32 s54, 0, s54
  s_cselect_b32 s56, 0, s56
  s_add_u32 m0, s55, 40960
  s_nop 0
  buffer_load_dwordx4 v4, s[32:35], s53 offen lds
  s_add_u32 m0, s55, 57216
  s_nop 0
  buffer_load_dwordx4 v4, s[32:35], s53 offen offset:128 lds
  s_add_u32 m0, s55, 73728
  s_add_u32 s53, s53, s52
  buffer_load_dwordx4 v7, s[36:39], s56 offen lds
  s_add_u32 m0, s55, 90112
  s_nop 0
  buffer_load_dwordx4 v7, s[12:15], s56 offen lds
  s_add_u32 m0, s55, 106496
  s_add_u32 s56, s56, 98304
  buffer_load_dwordx4 v5, s[40:43], s54 offen lds
  s_add_u32 s54, s54, 122880
  s_waitcnt lgkmcnt(0)
  v_mfma_f32_16x16x32_bf16 v[8:11], v[16:19], v[12:15], v[8:11]
  s_add_u32 m0, s81, 0
  s_nop 0
  buffer_load_dwordx4 v48, s[76:79], s80 offen lds
  s_add_u32 m0, s81, 1024
  s_nop 0
  buffer_load_dwordx4 v49, s[76:79], s80 offen lds
  s_add_u32 m0, s81, 2048
  s_nop 0
  buffer_load_dwordx4 v50, s[76:79], s80 offen lds
  s_add_u32 m0, s81, 3072
  s_nop 0
  buffer_load_dwordx4 v51, s[76:79], s80 offen lds
  s_add_u32 m0, s81, 4096
  s_nop 0
  buffer_load_dwordx4 v52, s[76:79], s80 offen lds
  s_waitcnt vmcnt(19)
  s_waitcnt vmcnt(15)
  s_barrier
  ds_read_b64_tr_b16 v[16:17], v6 offset:0
  ds_read_b64_tr_b16 v[18:19], v6 offset:512
  s_add_u32 m0, s57, 16384
  s_add_u32 s65, s59, 0
  buffer_load_dwordx4 v2, s[44:47], s65 offen lds
  buffer_load_dwordx4 v3, s[44:47], s65 offen offset:1024 lds
  s_add_u32 m0, s57, 18432
  s_add_u32 s65, s59, 20480
  buffer_load_dwordx4 v2, s[44:47], s65 offen lds
  buffer_load_dwordx4 v3, s[44:47], s65 offen offset:1024 lds
  s_add_u32 s59, s59, 128
  s_cmp_eq_u32 s59, 1280
  s_cselect_b32 s59, 0, s59
  s_add_u32 m0, s55, 45056
  s_nop 0
  buffer_load_dwordx4 v4, s[32:35], s53 offen lds
  s_add_u32 m0, s55, 61312
  s_nop 0
  buffer_load_dwordx4 v4, s[32:35], s53 offen offset:128 lds
  s_add_u32 m0, s55, 77824
  s_add_u32 s53, s53, s52
  buffer_load_dwordx4 v7, s[36:39], s56 offen lds
  s_waitcnt lgkmcnt(0)
  v_mfma_f32_16x16x32_bf16 v[8:11], v[16:19], v[12:15], v[8:11]
  s_waitcnt vmcnt(17)
  s_barrier
  ds_read_b64_tr_b16 v[16:17], v6 offset:4096
  ds_read_b64_tr_b16 v[18:19], v6 offset:4608
  s_add_u32 m0, s55, 94208
  s_nop 0
  buffer_load_dwordx4 v7, s[12:15], s56 offen lds
  s_add_u32 m0, s55, 110592
  s_add_u32 s56, s56, 98304
  buffer_load_dwordx4 v5, s[40:43], s54 offen lds
  s_add_u32 s54, s54, 122880
  s_cmp_eq_u32 s54, 2457600
  s_cselect_b32 s53, 0, s53
  s_cselect_b32 s54, 0, s54
  s_cselect_b32 s56, 0, s56
  s_add_u32 m0, s55, 32768
  s_nop 0
  buffer_load_dwordx4 v4, s[32:35], s53 offen lds
  s_add_u32 m0, s55, 49024
  s_nop 0
  buffer_load_dwordx4 v4, s[32:35], s53 offen offset:128 lds
  s_add_u32 m0, s55, 65536
  s_add_u32 s53, s53, s52
  buffer_load_dwordx4 v7, s[36:39], s56 offen lds
  s_add_u32 m0, s55, 81920
  s_nop 0
  buffer_load_dwordx4 v7, s[12:15], s56 offen lds
  s_add_u32 m0, s55, 98304
  s_add_u32 s56, s56, 98304
  buffer_load_dwordx4 v5, s[40:43], s54 offen lds
  s_add_u32 s54, s54, 122880
  s_waitcnt lgkmcnt(0)
  v_mfma_f32_16x16x32_bf16 v[8:11], v[16:19], v[12:15], v[8:11]
  buffer_load_dwordx4 v[96:99], v55, s[44:47], 0 offen offset:0
  buffer_load_dwordx4 v[100:103], v55, s[44:47], 0 offen offset:512
  buffer_load_dwordx4 v[104:107], v56, s[44:47], 0 offen offset:1024
  s_waitcnt vmcnt(22)
  s_waitcnt vmcnt(13)
  s_barrier
  ds_read_b64_tr_b16 v[16:17], v6 offset:8192
  ds_read_b64_tr_b16 v[18:19], v6 offset:8704
  s_add_u32 m0, s57, 0
  s_add_u32 s65, s59, 0
  buffer_load_dwordx4 v2, s[44:47], s65 offen lds
  buffer_load_dwordx4 v3, s[44:47], s65 offen offset:1024 lds
  s_add_u32 m0, s57, 2048
  s_add_u32 s65, s59, 20480
  buffer_load_dwordx4 v2, s[44:47], s65 offen lds
  buffer_load_dwordx4 v3, s[44:47], s65 offen offset:1024 lds
  s_add_u32 s59, s59, 128
  s_cmp_eq_u32 s59, 1280
  s_cselect_b32 s59, 0, s59
  s_add_u32 m0, s55, 36864
  s_nop 0
  buffer_load_dwordx4 v4, s[32:35], s53 offen lds
  s_add_u32 m0, s55, 53120
  s_nop 0
  buffer_load_dwordx4 v4, s[32:35], s53 offen offset:128 lds
  s_add_u32 m0, s55, 69632
  s_add_u32 s53, s53, s52
  buffer_load_dwordx4 v7, s[36:39], s56 offen lds
  s_waitcnt lgkmcnt(0)
  v_mfma_f32_16x16x32_bf16 v[8:11], v[16:19], v[12:15], v[8:11]
  v_mov_b32 v24, 155136
  ds_read_b32 v25, v24
  s_waitcnt lgkmcnt(0)
  v_readfirstlane_b32 s75, v25
  s_waitcnt vmcnt(15)
  s_barrier
  ds_read_b64_tr_b16 v[16:17], v6 offset:12288
  ds_read_b64_tr_b16 v[18:19], v6 offset:12800
  s_add_u32 m0, s55, 86016
  s_nop 0
  buffer_load_dwordx4 v7, s[12:15], s56 offen lds
  s_add_u32 m0, s55, 102400
  s_add_u32 s56, s56, 98304
  buffer_load_dwordx4 v5, s[40:43], s54 offen lds
  s_add_u32 s54, s54, 122880
  s_cmp_eq_u32 s54, 2457600
  s_cselect_b32 s53, 0, s53
  s_cselect_b32 s54, 0, s54
  s_cselect_b32 s56, 0, s56
  s_add_u32 m0, s55, 40960
  s_nop 0
  buffer_load_dwordx4 v4, s[32:35], s53 offen lds
  s_add_u32 m0, s55, 57216
  s_nop 0
  buffer_load_dwordx4 v4, s[32:35], s53 offen offset:128 lds
  s_add_u32 m0, s55, 73728
  s_add_u32 s53, s53, s52
  buffer_load_dwordx4 v7, s[36:39], s56 offen lds
  s_add_u32 m0, s55, 90112
  s_nop 0
  buffer_load_dwordx4 v7, s[12:15], s56 offen lds
  s_add_u32 m0, s55, 106496
  s_add_u32 s56, s56, 98304
  buffer_load_dwordx4 v5, s[40:43], s54 offen lds
  s_add_u32 s54, s54, 122880
  s_waitcnt lgkmcnt(0)
  v_mfma_f32_16x16x32_bf16 v[8:11], v[16:19], v[12:15], v[8:11]
  ds_read_b64_tr_b16 v[72:73], v53 offset:0
  ds_read_b64_tr_b16 v[74:75], v53 offset:2560
  ds_read_b64_tr_b16 v[76:77], v53 offset:8
  ds_read_b64_tr_b16 v[78:79], v53 offset:2568
  ds_read_b64_tr_b16 v[80:81], v53 offset:16
  ds_read_b64_tr_b16 v[82:83], v53 offset:2576
  ds_read_b64_tr_b16 v[84:85], v53 offset:24
  ds_read_b64_tr_b16 v[86:87], v53 offset:2584
  ds_read_b64_tr_b16 v[88:89], v53 offset:32
  ds_read_b64_tr_b16 v[90:91], v53 offset:2592
  s_waitcnt lgkmcnt(0)
  buffer_store_dwordx4 v[72:75], v54, s[28:31], s73 offen offset:0 sc1
  buffer_store_dwordx4 v[76:79], v54, s[28:31], s73 offen offset:1024 sc1
  buffer_store_dwordx4 v[80:83], v54, s[28:31], s73 offen offset:2048 sc1
  buffer_store_dwordx4 v[84:87], v54, s[28:31], s73 offen offset:3072 sc1
  buffer_store_dwordx4 v[88:91], v54, s[28:31], s74 offen sc1
  s_waitcnt vmcnt(22)
  s_waitcnt vmcnt(15)
  s_barrier
  ds_read_b64_tr_b16 v[16:17], v6 offset:0
  ds_read_b64_tr_b16 v[18:19], v6 offset:512
  s_add_u32 m0, s57, 16384
  s_add_u32 s65, s59, 0
  buffer_load_dwordx4 v2, s[44:47], s65 offen lds
  v_mov_b32 v92, 0
  v_mov_b32 v93, 0
  v_mov_b32 v94, 0
  v_mov_b32 v95, 0
  buffer_load_dwordx4 v3, s[44:47], s65 offen offset:1024 lds
  v_lshlrev_b32 v44, 16, v96
  v_and_b32 v45, 0xffff0000, v96
  v_add_f32 v92, v92, v44
  v_fmac_f32 v93, v44, v44
  s_add_u32 m0, s57, 18432
  s_add_u32 s65, s59, 20480
  buffer_load_dwordx4 v2, s[44:47], s65 offen lds
  v_add_f32 v94, v94, v45
  v_fmac_f32 v95, v45, v45
  v_lshlrev_b32 v44, 16, v97
  v_and_b32 v45, 0xffff0000, v97
  buffer_load_dwordx4 v3, s[44:47], s65 offen offset:1024 lds
  v_add_f32 v92, v92, v44
  v_fmac_f32 v93, v44, v44
  v_add_f32 v94, v94, v45
  v_fmac_f32 v95, v45, v45
  s_add_u32 s59, s59, 128
  s_cmp_eq_u32 s59, 1280
  s_cselect_b32 s59, 0, s59
  s_add_u32 m0, s55, 45056
  s_nop 0
  buffer_load_dwordx4 v4, s[32:35], s53 offen lds
  v_lshlrev_b32 v44, 16, v98
  v_and_b32 v45, 0xffff0000, v98
  v_add_f32 v92, v92, v44
  v_fmac_f32 v93, v44, v44
  s_add_u32 m0, s55, 61312
  s_nop 0
  buffer_load_dwordx4 v4, s[32:35], s53 offen offset:128 lds
  v_add_f32 v94, v94, v45
  v_fmac_f32 v95, v45, v45
  v_lshlrev_b32 v44, 16, v99
  v_and_b32 v45, 0xffff0000, v99
  s_add_u32 m0, s55, 77824
  s_add_u32 s53, s53, s52
  buffer_load_dwordx4 v7, s[36:39], s56 offen lds
  v_add_f32 v92, v92, v44
  v_fmac_f32 v93, v44, v44
  v_add_f32 v94, v94, v45
  v_fmac_f32 v95, v45, v45
  s_waitcnt lgkmcnt(0)
  v_mfma_f32_16x16x32_bf16 v[8:11], v[16:19], v[12:15], v[8:11]
  s_waitcnt vmcnt(17)
  s_barrier
  ds_read_b64_tr_b16 v[16:17], v6 offset:4096
  ds_read_b64_tr_b16 v[18:19], v6 offset:4608
  s_add_u32 m0, s55, 94208
  s_nop 0
  buffer_load_dwordx4 v7, s[12:15], s56 offen lds
  v_lshlrev_b32 v44, 16, v100
  v_and_b32 v45, 0xffff0000, v100
  v_add_f32 v92, v92, v44
  v_fmac_f32 v93, v44, v44
  s_add_u32 m0, s55, 110592
  s_add_u32 s56, s56, 98304
  buffer_load_dwordx4 v5, s[40:43], s54 offen lds
  v_add_f32 v94, v94, v45
  v_fmac_f32 v95, v45, v45
  v_lshlrev_b32 v44, 16, v101
  v_and_b32 v45, 0xffff0000, v101
  s_add_u32 s54, s54, 122880
  s_cmp_eq_u32 s54, 2457600
  s_cselect_b32 s53, 0, s53
  s_cselect_b32 s54, 0, s54
  s_cselect_b32 s56, 0, s56
  s_add_u32 m0, s55, 32768
  s_nop 0
  buffer_load_dwordx4 v4, s[32:35], s53 offen lds
  v_add_f32 v92, v92, v44
  v_fmac_f32 v93, v44, v44
  v_add_f32 v94, v94, v45
  v_fmac_f32 v95, v45, v45
  s_add_u32 m0, s55, 49024
  s_nop 0
  buffer_load_dwordx4 v4, s[32:35], s53 offen offset:128 lds
  v_lshlrev_b32 v44, 16, v102
  v_and_b32 v45, 0xffff0000, v102
  v_add_f32 v92, v92, v44
  v_fmac_f32 v93, v44, v44
  s_add_u32 m0, s55, 65536
  s_add_u32 s53, s53, s52
  buffer_load_dwordx4 v7, s[36:39], s56 offen lds
  v_add_f32 v94, v94, v45
  v_fmac_f32 v95, v45, v45
  v_lshlrev_b32 v44, 16, v103
  v_and_b32 v45, 0xffff0000, v103
  s_add_u32 m0, s55, 81920
  s_nop 0
  buffer_load_dwordx4 v7, s[12:15], s56 offen lds
  v_add_f32 v92, v92, v44
  v_fmac_f32 v93, v44, v44
  v_add_f32 v94, v94, v45
  v_fmac_f32 v95, v45, v45
  s_add_u32 m0, s55, 98304
  s_add_u32 s56, s56, 98304
  buffer_load_dwordx4 v5, s[40:43], s54 offen lds
  s_add_u32 s54, s54, 122880
  s_waitcnt lgkmcnt(0)
  v_mfma_f32_16x16x32_bf16 v[8:11], v[16:19], v[12:15], v[8:11]
  s_waitcnt vmcnt(14)
  s_waitcnt vmcnt(10)
  s_barrier
  s_add_u32 m0, s57, 0
  s_add_u32 s65, s59, 0
  buffer_load_dwordx4 v2, s[44:47], s65 offen lds
  v_lshlrev_b32 v44, 16, v104
  v_and_b32 v45, 0xffff0000, v104
  v_add_f32 v92, v92, v44
  v_fmac_f32 v93, v44, v44
  buffer_load_dwordx4 v3, s[44:47], s65 offen offset:1024 lds
  v_add_f32 v94, v94, v45
  v_fmac_f32 v95, v45, v45
  v_lshlrev_b32 v44, 16, v105
  v_and_b32 v45, 0xffff0000, v105
  s_add_u32 m0, s57, 2048
  s_add_u32 s65, s59, 20480
  buffer_load_dwordx4 v2, s[44:47], s65 offen lds
  v_add_f32 v92, v92, v44
  v_fmac_f32 v93, v44, v44
  v_add_f32 v94, v94, v45
  v_fmac_f32 v95, v45, v45
  buffer_load_dwordx4 v3, s[44:47], s65 offen offset:1024 lds
  v_lshlrev_b32 v44, 16, v106
  v_and_b32 v45, 0xffff0000, v106
  v_add_f32 v92, v92, v44
  v_fmac_f32 v93, v44, v44
  s_add_u32 s59, s59, 128
  s_cmp_eq_u32 s59, 1280
  s_cselect_b32 s59, 0, s59
  s_add_u32 m0, s55, 36864
  s_nop 0
  buffer_load_dwordx4 v4, s[32:35], s53 offen lds
  v_add_f32 v94, v94, v45
  v_fmac_f32 v95, v45, v45
  v_lshlrev_b32 v44, 16, v107
  v_and_b32 v45, 0xffff0000, v107
  s_add_u32 m0, s55, 53120
  s_nop 0
  buffer_load_dwordx4 v4, s[32:35], s53 offen offset:128 lds
  v_add_f32 v92, v92, v44
  v_fmac_f32 v93, v44, v44
  v_add_f32 v94, v94, v45
  v_fmac_f32 v95, v45, v45
  s_add_u32 m0, s55, 69632
  s_add_u32 s53, s53, s52
  buffer_load_dwordx4 v7, s[36:39], s56 offen lds
  s_lshl_b32 s48, s2, 2
  s_add_u32 s48, s48, 19693568
  s_cmp_eq_u32 s50, 0
  s_cselect_b32 s48, s48, 1073741824
  v_mov_b32 v17, 0
  v_mov_b32 v23, s75
  s_mov_b64 exec, 1
  buffer_store_dword v23, v17, s[28:31], s48 offen sc1
  s_mov_b64 exec, -1
  s_waitcnt vmcnt(13)
  s_barrier
  s_add_u32 m0, s55, 86016
  s_nop 0
  buffer_load_dwordx4 v7, s[12:15], s56 offen lds
  v_add_f32 v92, v92, v94
  v_add_f32 v93, v93, v95
  s_nop 1
  v_add_f32_dpp v92, v92, v92 row_ror:8 row_mask:0xf bank_mask:0xf
  v_add_f32_dpp v93, v93, v93 row_ror:8 row_mask:0xf bank_mask:0xf
  s_nop 1
  s_add_u32 m0, s55, 102400
  s_add_u32 s56, s56, 98304
  buffer_load_dwordx4 v5, s[40:43], s54 offen lds
  v_add_f32_dpp v92, v92, v92 row_ror:4 row_mask:0xf bank_mask:0xf
  v_add_f32_dpp v93, v93, v93 row_ror:4 row_mask:0xf bank_mask:0xf
  s_nop 1
  v_add_f32_dpp v92, v92, v92 row_ror:2 row_mask:0xf bank_mask:0xf
  v_add_f32_dpp v93, v93, v93 row_ror:2 row_mask:0xf bank_mask:0xf
  s_nop 1
  s_add_u32 s54, s54, 122880
  s_cmp_eq_u32 s54, 2457600
  s_cselect_b32 s53, 0, s53
  s_cselect_b32 s54, 0, s54
  s_cselect_b32 s56, 0, s56
  s_add_u32 m0, s55, 40960
  s_nop 0
  buffer_load_dwordx4 v4, s[32:35], s53 offen lds
  v_add_f32_dpp v92, v92, v92 row_ror:1 row_mask:0xf bank_mask:0xf
  v_add_f32_dpp v93, v93, v93 row_ror:1 row_mask:0xf bank_mask:0xf
  v_mov_b32 v94, v92
  v_mov_b32 v95, v93
  s_nop 1
  v_permlane16_swap_b32 v92, v94
  s_add_u32 m0, s55, 57216
  s_nop 0
  buffer_load_dwordx4 v4, s[32:35], s53 offen offset:128 lds
  v_permlane16_swap_b32 v93, v95
  s_nop 1
  v_add_f32 v92, v92, v94
  v_add_f32 v93, v93, v95
  s_mov_b32 s48, 986500301
  v_mul_f32 v92, s48, v92
  s_add_u32 m0, s55, 73728
  s_add_u32 s53, s53, s52
  buffer_load_dwordx4 v7, s[36:39], s56 offen lds
  v_mul_f32 v93, s48, v93
  v_fma_f32 v93, -v92, v92, v93
  v_max_f32 v93, 0, v93
  v_cvt_pk_bf16_f32 v44, v93, v93
  v_lshlrev_b32 v44, 16, v44
  v_add_f32 v44, 925353388, v44
  s_add_u32 m0, s55, 90112
  s_nop 0
  buffer_load_dwordx4 v7, s[12:15], s56 offen lds
  v_cvt_pk_bf16_f32 v44, v44, v44
  v_lshlrev_b32 v44, 16, v44
  v_sqrt_f32 v44, v44
  s_nop 0
  v_cvt_pk_bf16_f32 v44, v44, v44
  v_lshlrev_b32 v98, 16, v44
  s_add_u32 m0, s55, 106496
  s_add_u32 s56, s56, 98304
  buffer_load_dwordx4 v5, s[40:43], s54 offen lds
  v_rcp_f32 v97, v98
  v_sub_f32 v92, 0, v92
  v_cvt_pk_bf16_f32 v44, v92, v92
  v_lshlrev_b32 v96, 16, v44
  s_add_u32 s54, s54, 122880
  s_waitcnt vmcnt(15)
  s_waitcnt vmcnt(11)
  s_barrier
  s_add_u32 m0, s57, 16384
  s_add_u32 s65, s59, 0
  buffer_load_dwordx4 v2, s[44:47], s65 offen lds
  buffer_load_dwordx4 v3, s[44:47], s65 offen offset:1024 lds
  s_add_u32 m0, s57, 18432
  s_add_u32 s65, s59, 20480
  buffer_load_dwordx4 v2, s[44:47], s65 offen lds
  buffer_load_dwordx4 v3, s[44:47], s65 offen offset:1024 lds
  s_add_u32 s59, s59, 128
  s_cmp_eq_u32 s59, 1280
  s_cselect_b32 s59, 0, s59
  s_add_u32 m0, s55, 45056
  s_nop 0
  buffer_load_dwordx4 v4, s[32:35], s53 offen lds
  s_add_u32 m0, s55, 61312
  s_nop 0
  buffer_load_dwordx4 v4, s[32:35], s53 offen offset:128 lds
  s_add_u32 m0, s55, 77824
  s_add_u32 s53, s53, s52
  buffer_load_dwordx4 v7, s[36:39], s56 offen lds
  v_lshrrev_b32 v26, 5, v0
  v_lshlrev_b32 v26, 4, v26
  s_lshl_b32 s48, s24, 4
  s_add_u32 s48, s48, s25
  s_lshl_b32 s48, s48, 2
  s_add_u32 s48, s48, s50
  s_lshl_b32 s48, s48, 5
  s_add_u32 s48, s48, 19644416
  s_mov_b32 s66, 1
  s_mov_b32 s67, 1
  v_mov_b32 v99, s75
  s_mov_b64 exec, s[66:67]
  buffer_store_dwordx4 v[96:99], v26, s[28:31], s48 offen sc1
  s_mov_b64 exec, -1
  v_mov_b32 v32, v8
  v_mov_b32 v33, v9
  v_mov_b32 v34, s75
  v_mov_b32 v35, s75
  v_mov_b32 v36, v10
  v_mov_b32 v37, v11
  v_mov_b32 v38, s75
  v_mov_b32 v39, s75
  v_lshrrev_b32 v24, 4, v0
  v_lshlrev_b32 v24, 5, v24
  s_mul_i32 s48, s25, 5120
  s_mul_i32 s49, s82, 2560
  s_add_u32 s48, s48, s49
  s_lshl_b32 s49, s60, 7
  s_add_u32 s48, s48, s49
  s_add_u32 s48, s48, 19562496
  s_cmp_eq_u32 s61, 1
  s_cselect_b32 s48, s48, 1073741824
  s_mov_b32 s66, 0x00010001
  s_mov_b32 s67, 0x00010001
  s_mov_b64 exec, s[66:67]
  buffer_store_dwordx4 v[32:35], v24, s[28:31], s48 offen sc1
  buffer_store_dwordx4 v[36:39], v24, s[28:31], s48 offen offset:16 sc1
  s_mov_b64 exec, -1
  s_waitcnt vmcnt(15)
  s_barrier
  s_add_u32 m0, s55, 94208
  s_nop 0
  buffer_load_dwordx4 v7, s[12:15], s56 offen lds
  s_add_u32 m0, s55, 110592
  s_add_u32 s56, s56, 98304
  buffer_load_dwordx4 v5, s[40:43], s54 offen lds
  s_add_u32 s54, s54, 122880
  s_cmp_eq_u32 s54, 2457600
  s_cselect_b32 s53, 0, s53
  s_cselect_b32 s54, 0, s54
  s_cselect_b32 s56, 0, s56
  s_add_u32 m0, s55, 32768
  s_nop 0
  buffer_load_dwordx4 v4, s[32:35], s53 offen lds
  s_add_u32 m0, s55, 49024
  s_nop 0
  buffer_load_dwordx4 v4, s[32:35], s53 offen offset:128 lds
  s_add_u32 m0, s55, 65536
  s_add_u32 s53, s53, s52
  buffer_load_dwordx4 v7, s[36:39], s56 offen lds
  s_add_u32 m0, s55, 81920
  s_nop 0
  buffer_load_dwordx4 v7, s[12:15], s56 offen lds
  s_add_u32 m0, s55, 98304
  s_add_u32 s56, s56, 98304
  buffer_load_dwordx4 v5, s[40:43], s54 offen lds
  s_add_u32 s54, s54, 122880
  s_waitcnt vmcnt(17)
  s_waitcnt vmcnt(13)
  s_barrier
  s_add_u32 m0, s57, 0
  s_add_u32 s65, s59, 0
  buffer_load_dwordx4 v2, s[44:47], s65 offen lds
  buffer_load_dwordx4 v3, s[44:47], s65 offen offset:1024 lds
  s_add_u32 m0, s57, 2048
  s_add_u32 s65, s59, 20480
  buffer_load_dwordx4 v2, s[44:47], s65 offen lds
  buffer_load_dwordx4 v3, s[44:47], s65 offen offset:1024 lds
  s_add_u32 s59, s59, 128
  s_cmp_eq_u32 s59, 1280
  s_cselect_b32 s59, 0, s59
  s_add_u32 m0, s55, 36864
  s_nop 0
  buffer_load_dwordx4 v4, s[32:35], s53 offen lds
  s_add_u32 m0, s55, 53120
  s_nop 0
  buffer_load_dwordx4 v4, s[32:35], s53 offen offset:128 lds
  s_add_u32 m0, s55, 69632
  s_add_u32 s53, s53, s52
  buffer_load_dwordx4 v7, s[36:39], s56 offen lds
  s_waitcnt vmcnt(12)
  s_barrier
  s_add_u32 m0, s55, 86016
  s_nop 0
  buffer_load_dwordx4 v7, s[12:15], s56 offen lds
  s_add_u32 m0, s55, 102400
  s_add_u32 s56, s56, 98304
  buffer_load_dwordx4 v5, s[40:43], s54 offen lds
  s_add_u32 s54, s54, 122880
  s_cmp_eq_u32 s54, 2457600
  s_cselect_b32 s53, 0, s53
  s_cselect_b32 s54, 0, s54
  s_cselect_b32 s56, 0, s56
  s_add_u32 m0, s55, 40960
  s_nop 0
  buffer_load_dwordx4 v4, s[32:35], s53 offen lds
  s_add_u32 m0, s55, 57216
  s_nop 0
  buffer_load_dwordx4 v4, s[32:35], s53 offen offset:128 lds
  s_add_u32 m0, s55, 73728
  s_add_u32 s53, s53, s52
  buffer_load_dwordx4 v7, s[36:39], s56 offen lds
  s_add_u32 m0, s55, 90112
  s_nop 0
  buffer_load_dwordx4 v7, s[12:15], s56 offen lds
  s_add_u32 m0, s55, 106496
  s_add_u32 s56, s56, 98304
  buffer_load_dwordx4 v5, s[40:43], s54 offen lds
  s_add_u32 s54, s54, 122880
  s_waitcnt vmcnt(14)
  s_waitcnt vmcnt(10)
  s_barrier
  s_add_u32 m0, s57, 16384
  s_add_u32 s65, s59, 0
  buffer_load_dwordx4 v2, s[44:47], s65 offen lds
  buffer_load_dwordx4 v3, s[44:47], s65 offen offset:1024 lds
  s_add_u32 m0, s57, 18432
  s_add_u32 s65, s59, 20480
  buffer_load_dwordx4 v2, s[44:47], s65 offen lds
  buffer_load_dwordx4 v3, s[44:47], s65 offen offset:1024 lds
  s_add_u32 s59, s59, 128
  s_cmp_eq_u32 s59, 1280
  s_cselect_b32 s59, 0, s59
  s_add_u32 m0, s55, 45056
  s_nop 0
  buffer_load_dwordx4 v4, s[32:35], s53 offen lds
  s_add_u32 m0, s55, 61312
  s_nop 0
  buffer_load_dwordx4 v4, s[32:35], s53 offen offset:128 lds
  s_add_u32 m0, s55, 77824
  s_add_u32 s53, s53, s52
  buffer_load_dwordx4 v7, s[36:39], s56 offen lds
  s_waitcnt vmcnt(12)
  s_barrier
  s_add_u32 m0, s55, 94208
  s_nop 0
  buffer_load_dwordx4 v7, s[12:15], s56 offen lds
  s_add_u32 m0, s55, 110592
  s_add_u32 s56, s56, 98304
  buffer_load_dwordx4 v5, s[40:43], s54 offen lds
  s_add_u32 s54, s54, 122880
  s_cmp_eq_u32 s54, 2457600
  s_cselect_b32 s53, 0, s53
  s_cselect_b32 s54, 0, s54
  s_cselect_b32 s56, 0, s56
  v_and_b32 v24, 31, v0
  v_add_u32 v24, s62, v24
  v_lshlrev_b32 v24, 4, v24
  v_min_u32 v25, 39, v0
  s_mul_i32 s48, s50, 40
  v_add_u32 v25, s48, v25
  v_lshlrev_b32 v25, 4, v25
  s_lshl_b32 s66, s24, 11
  s_add_u32 s66, s66, 19644416
  s_mul_i32 s67, s25, 5120
  s_add_u32 s67, s67, 19562496
  buffer_load_dwordx4 v[28:31], v24, s[28:31], s66 offen sc1
  buffer_load_dwordx4 v[32:35], v25, s[28:31], s67 offen sc1
  buffer_load_dwordx4 v[36:39], v25, s[28:31], s67 offen offset:2560 sc1
  s_waitcnt vmcnt(12)
  s_waitcnt vmcnt(8)
  s_barrier
  s_waitcnt vmcnt(0)
  s_mov_b32 s68, 0
L_fin_r_2:
  v_xor_b32 v26, s75, v31
  v_xor_b32 v27, s75, v34
  v_or_b32 v26, v26, v27
  v_xor_b32 v27, s75, v38
  v_or_b32 v26, v26, v27
  v_cmp_ne_u32 vcc, 0, v26
  s_cbranch_vccz L_fin_ok_3
  s_add_u32 s68, s68, 1
  s_cmp_ge_u32 s68, 30000
  s_cbranch_scc1 L_fin_ok_3
  s_sleep 8
  buffer_load_dwordx4 v[28:31], v24, s[28:31], s66 offen sc1
  buffer_load_dwordx4 v[32:35], v25, s[28:31], s67 offen sc1
  buffer_load_dwordx4 v[36:39], v25, s[28:31], s67 offen offset:2560 sc1
  s_waitcnt vmcnt(0)
  s_branch L_fin_r_2
L_fin_ok_3:
  v_add_u32 v26, 153088, v24
  ds_write_b128 v26, v[28:31]
  v_add_f32 v32, v32, v36
  v_add_f32 v33, v33, v37
  v_lshrrev_b32 v26, 1, v25
  v_add_u32 v26, 151808, v26
  ds_write_b64 v26, v[32:33]
  s_waitcnt lgkmcnt(0)
  s_barrier
  v_lshlrev_b32 v104, 4, v0
  s_mov_b32 s69, 19693568
  buffer_load_dwordx4 v[100:103], v104, s[28:31], s69 offen sc1
  s_barrier
  s_setprio 0
  s_and_b32 s32, s26, 1
  s_lshl_b32 s32, s32, 4
  s_bfe_u32 s48, s26, 0x10001
  s_lshl_b32 s48, s48, 3
  s_add_u32 s32, s32, s48
  s_and_b32 s48, s27, 7
  s_add_u32 s32, s32, s48
  s_lshr_b32 s33, s26, 2
  s_lshl_b32 s33, s33, 2
  s_lshr_b32 s49, s27, 3
  s_add_u32 s33, s33, s49
  v_lshlrev_b32 v2, 4, v0
  v_add_u32 v3, 4096, v2
  s_mul_i32 s36, s33, 348160
  s_mul_i32 s48, s50, 5120
  s_add_u32 s36, s36, s48
  s_add_u32 s36, s36, 16777216
  s_mul_i32 s53, s50, 25600
  s_add_u32 s53, s53, 49408
  v_mov_b32 v17, 0
  v_mov_b32 v23, s75
  s_waitcnt vmcnt(0)
  s_mov_b32 s68, 0
L_pw_r_4:
  v_xor_b32 v105, s75, v100
  v_xor_b32 v106, s75, v101
  v_or_b32 v105, v105, v106
  v_xor_b32 v106, s75, v102
  v_or_b32 v105, v105, v106
  v_xor_b32 v106, s75, v103
  v_or_b32 v105, v105, v106
  v_cmp_ne_u32 vcc, 0, v105
  s_cbranch_vccz L_pw_ok_5
  s_add_u32 s68, s68, 1
  s_cmp_ge_u32 s68, 30000
  s_cbranch_scc1 L_pw_ok_5
  s_sleep 16
  buffer_load_dwordx4 v[100:103], v104, s[28:31], s69 offen sc1
  s_waitcnt vmcnt(0)
  s_branch L_pw_r_4
L_pw_ok_5:
  v_mov_b32 v13, 155160
  s_mov_b32 s48, 0
L_wst_w_6:
  ds_read_b32 v14, v13
  s_waitcnt lgkmcnt(0)
  v_readfirstlane_b32 s49, v14
  s_cmp_ge_u32 s49, 4
  s_cbranch_scc1 L_wst_g_7
  s_add_u32 s48, s48, 1
  s_cmp_ge_u32 s48, 1200000
  s_cbranch_scc1 L_wst_g_7
  s_sleep 4
  s_branch L_wst_w_6
L_wst_g_7:
  s_add_u32 m0, s53, 0
  s_add_u32 s48, s36, 245760
  buffer_load_dwordx4 v2, s[28:31], s48 offen offset:0 sc1 lds
  buffer_load_dwordx4 v2, s[28:31], s48 offen offset:1024 sc1 lds
  buffer_load_dwordx4 v2, s[28:31], s48 offen offset:2048 sc1 lds
  buffer_load_dwordx4 v2, s[28:31], s48 offen offset:3072 sc1 lds
  s_add_u32 m0, s53, 4096
  s_nop 0
  buffer_load_dwordx4 v3, s[28:31], s48 offen sc1 lds
  s_add_u32 m0, s53, 5120
  s_add_u32 s48, s36, 266240
  buffer_load_dwordx4 v2, s[28:31], s48 offen offset:0 sc1 lds
  buffer_load_dwordx4 v2, s[28:31], s48 offen offset:1024 sc1 lds
  buffer_load_dwordx4 v2, s[28:31], s48 offen offset:2048 sc1 lds
  buffer_load_dwordx4 v2, s[28:31], s48 offen offset:3072 sc1 lds
  s_add_u32 m0, s53, 9216
  s_nop 0
  buffer_load_dwordx4 v3, s[28:31], s48 offen sc1 lds
  s_add_u32 m0, s53, 10240
  s_add_u32 s48, s36, 286720
  buffer_load_dwordx4 v2, s[28:31], s48 offen offset:0 sc1 lds
  buffer_load_dwordx4 v2, s[28:31], s48 offen offset:1024 sc1 lds
  buffer_load_dwordx4 v2, s[28:31], s48 offen offset:2048 sc1 lds
  buffer_load_dwordx4 v2, s[28:31], s48 offen offset:3072 sc1 lds
  s_add_u32 m0, s53, 14336
  s_nop 0
  buffer_load_dwordx4 v3, s[28:31], s48 offen sc1 lds
  s_add_u32 m0, s53, 15360
  s_add_u32 s48, s36, 307200
  buffer_load_dwordx4 v2, s[28:31], s48 offen offset:0 sc1 lds
  buffer_load_dwordx4 v2, s[28:31], s48 offen offset:1024 sc1 lds
  buffer_load_dwordx4 v2, s[28:31], s48 offen offset:2048 sc1 lds
  buffer_load_dwordx4 v2, s[28:31], s48 offen offset:3072 sc1 lds
  s_add_u32 m0, s53, 19456
  s_nop 0
  buffer_load_dwordx4 v3, s[28:31], s48 offen sc1 lds
  s_add_u32 m0, s53, 20480
  s_add_u32 s48, s36, 327680
  buffer_load_dwordx4 v2, s[28:31], s48 offen offset:0 sc1 lds
  buffer_load_dwordx4 v2, s[28:31], s48 offen offset:1024 sc1 lds
  buffer_load_dwordx4 v2, s[28:31], s48 offen offset:2048 sc1 lds
  buffer_load_dwordx4 v2, s[28:31], s48 offen offset:3072 sc1 lds
  s_add_u32 m0, s53, 24576
  s_nop 0
  buffer_load_dwordx4 v3, s[28:31], s48 offen sc1 lds
  s_lshl_b32 s32, s26, 2
  s_and_b32 s48, s27, 3
  s_add_u32 s32, s32, s48
  s_lshr_b32 s33, s27, 2
  s_and_b32 s34, s32, 1
  s_mul_i32 s40, s32, 5
  s_lshr_b32 s40, s40, 1
  v_lshlrev_b32 v56, 4, v0
  v_and_b32 v57, 7, v0
  v_min_u32 v57, 5, v57
  v_lshrrev_b32 v58, 1, v57
  v_mul_u32_u24 v58, 80, v58
  v_and_b32 v57, 1, v57
  v_lshl_add_u32 v58, v57, 1, v58
  v_add_u32 v58, s40, v58
  v_lshrrev_b32 v58, 3, v58
  v_subrev_u32 v57, 8, v58
  v_mul_u32_u24 v57, 43, v57
  v_lshrrev_b32 v57, 7, v57
  v_add_u32 v57, 8, v57
  v_cmp_gt_u32 vcc, 8, v58
  s_lshl_b32 s48, s33, 1
  s_sub_u32 s48, s48, 2
  v_cndmask_b32 v58, v57, v58, vcc
  v_bfe_u32 v57, v0, 3, 2
  v_add_u32 v57, s48, v57
  v_max_i32 v57, 0, v57
  v_lshlrev_b32 v58, 2, v58
  v_lshl_add_u32 v57, v57, 7, v58
  s_mov_b32 s41, 19677184
  s_lshl_b32 s49, s40, 10
  s_lshl_b32 s48, s33, 2
  s_lshl_b32 s44, s50, 1
  s_add_u32 s48, s48, s44
  s_sub_u32 s48, s48, 4
  s_mul_i32 s43, s48, 245760
  s_add_u32 s43, s43, s49
  s_cmp_lt_i32 s48, 0
  s_cselect_b32 s43, 1073741824, s43
  s_cselect_b32 s48, 0xf149, 0
  v_mov_b32 v62, s48
  v_mov_b32 v63, 0
  v_mov_b32 v64, 0x3f803f80
  v_mov_b32 v65, 0x3f803f80
  s_lshl_b32 s44, s50, 11
  s_cmp_eq_u32 s34, 0
  s_cselect_b32 s48, 16520, 0
  s_cselect_b32 s45, 16392, 0
  s_add_u32 s48, s48, s44
  s_add_u32 s48, s48, 24576
  s_add_u32 s45, s45, s44
  v_add_u32 v66, s48, v56
  v_add_u32 v67, s45, v56
  v_mov_b32 v70, 155140
  v_mov_b32 v71, 1
  s_mov_b32 s68, 0
  s_cmp_lg_u32 s50, 0
  s_cbranch_scc1 L_pq_o_8
  buffer_load_dword v58, v57, s[28:31], s41 offen sc1
  s_waitcnt vmcnt(0)
  s_mov_b32 s68, 0
L_pq_r_10:
  v_xor_b32 v60, s75, v58
  v_cmp_ne_u32 vcc, 0, v60
  s_cbranch_vccz L_pq_ok_11
  s_add_u32 s68, s68, 1
  s_cmp_ge_u32 s68, 30000
  s_cbranch_scc1 L_pq_ok_11
  s_sleep 4
  buffer_load_dword v58, v57, s[28:31], s41 offen sc1
  s_waitcnt vmcnt(0)
  s_branch L_pq_r_10
L_pq_ok_11:
  v_mov_b32 v60, 155152
  v_mov_b32 v61, 1
  ds_write_b32 v60, v61
  s_branch L_pq_d_9
L_pq_o_8:
  v_mov_b32 v60, 155152
  s_mov_b32 s48, 0
L_pq_w_12:
  ds_read_b32 v61, v60
  s_waitcnt lgkmcnt(0)
  v_readfirstlane_b32 s49, v61
  s_cmp_ge_u32 s49, 1
  s_cbranch_scc1 L_pq_g_13
  s_add_u32 s48, s48, 1
  s_cmp_ge_u32 s48, 1200000
  s_cbranch_scc1 L_pq_g_13
  s_sleep 2
  s_branch L_pq_w_12
L_pq_g_13:
L_pq_d_9:
  s_add_u32 m0, s44, 0
  s_add_u32 s45, s43, 81920
  buffer_load_dwordx4 v56, s[28:31], s45 offen sc1 lds
  s_add_u32 m0, s44, 8192
  s_add_u32 s45, s43, 82944
  buffer_load_dwordx4 v56, s[28:31], s45 offen sc1 lds
  s_add_u32 m0, s44, 16384
  s_add_u32 s45, s43, 83968
  buffer_load_dwordx4 v56, s[28:31], s45 offen sc1 lds
  s_add_u32 m0, s44, 24576
  s_add_u32 s45, s43, 163840
  buffer_load_dwordx4 v56, s[28:31], s45 offen sc1 lds
  s_add_u32 m0, s44, 32832
  s_add_u32 s45, s43, 164864
  buffer_load_dwordx4 v56, s[28:31], s45 offen sc1 lds
  s_add_u32 m0, s44, 41088
  s_add_u32 s45, s43, 165888
  buffer_load_dwordx4 v56, s[28:31], s45 offen sc1 lds
  s_add_u32 m0, s44, 1024
  s_add_u32 s45, s43, 327680
  buffer_load_dwordx4 v56, s[28:31], s45 offen sc1 lds
  s_add_u32 m0, s44, 9216
  s_add_u32 s45, s43, 328704
  buffer_load_dwordx4 v56, s[28:31], s45 offen sc1 lds
  s_add_u32 m0, s44, 17408
  s_add_u32 s45, s43, 329728
  buffer_load_dwordx4 v56, s[28:31], s45 offen sc1 lds
  s_add_u32 m0, s44, 25600
  s_add_u32 s45, s43, 409600
  buffer_load_dwordx4 v56, s[28:31], s45 offen sc1 lds
  s_add_u32 m0, s44, 33856
  s_add_u32 s45, s43, 410624
  buffer_load_dwordx4 v56, s[28:31], s45 offen sc1 lds
  s_add_u32 m0, s44, 42112
  s_add_u32 s45, s43, 411648
  buffer_load_dwordx4 v56, s[28:31], s45 offen sc1 lds
  s_waitcnt vmcnt(0)
  ds_write_b64 v66, v[64:65]
  ds_write_b64 v67, v[62:63]
  ds_write_b64 v66, v[64:65] offset:1024
  ds_write_b64 v67, v[62:63] offset:1024
  s_waitcnt lgkmcnt(0)
  s_mov_b64 exec, 1
  ds_add_u32 v70, v71
  s_mov_b64 exec, -1
  s_and_b32 s32, s26, 1
  s_lshl_b32 s32, s32, 4
  s_bfe_u32 s48, s26, 0x10001
  s_lshl_b32 s48, s48, 3
  s_add_u32 s32, s32, s48
  s_and_b32 s48, s27, 7
  s_add_u32 s32, s32, s48
  s_lshr_b32 s33, s26, 2
  s_lshl_b32 s33, s33, 2
  s_lshr_b32 s49, s27, 3
  s_add_u32 s33, s33, s49
  v_lshlrev_b32 v2, 4, v0
  v_add_u32 v3, 4096, v2
  s_mul_i32 s36, s33, 348160
  s_mul_i32 s48, s50, 5120
  s_add_u32 s36, s36, s48
  s_add_u32 s36, s36, 16777216
  s_mul_i32 s53, s50, 25600
  s_add_u32 s53, s53, 49408
  s_mul_i32 s51, s49, 3
  s_and_b32 s48, s27, 7
  s_mul_i32 s48, s48, 3
  s_lshr_b32 s48, s48, 1
  s_add_u32 s51, s51, s48
  s_cmp_ge_u32 s51, 12
  s_cselect_b32 s48, 12, 0
  s_sub_u32 s51, s51, s48
  s_mov_b32 s52, s51
  v_and_b32 v8, 15, v0
  v_lshrrev_b32 v9, 4, v0
  v_lshlrev_b32 v4, 4, v8
  v_lshl_add_u32 v4, v9, 10, v4
  s_mul_i32 s37, s32, 196608
  s_lshl_b32 s49, s50, 12
  s_add_u32 s37, s37, s49
  s_add_u32 s37, s37, 7864320
  s_lshr_b32 s48, s32, 1
  s_lshl_b32 s48, s48, 7
  s_add_u32 s35, s48, 19681280
  v_and_b32 v11, 15, v0
  v_lshlrev_b32 v11, 2, v11
  buffer_load_dword v1, v11, s[28:31], s35 offen sc1
  s_mul_i32 s54, s52, 20480
  s_add_u32 s54, s54, s36
  buffer_load_dwordx4 v[76:79], v2, s[28:31], s54 offen sc1
  buffer_load_dwordx4 v[80:83], v2, s[28:31], s54 offen offset:1024 sc1
  buffer_load_dwordx4 v[84:87], v2, s[28:31], s54 offen offset:2048 sc1
  buffer_load_dwordx4 v[88:91], v2, s[28:31], s54 offen offset:3072 sc1
  buffer_load_dwordx4 v[92:95], v3, s[28:31], s54 offen sc1
  s_add_u32 s52, s52, 1
  s_cmp_eq_u32 s52, 12
  s_cselect_b32 s52, 0, s52
  s_mul_i32 s54, s52, 20480
  s_add_u32 s54, s54, s36
  buffer_load_dwordx4 v[96:99], v2, s[28:31], s54 offen sc1
  buffer_load_dwordx4 v[100:103], v2, s[28:31], s54 offen offset:1024 sc1
  buffer_load_dwordx4 v[104:107], v2, s[28:31], s54 offen offset:2048 sc1
  buffer_load_dwordx4 v[108:111], v2, s[28:31], s54 offen offset:3072 sc1
  buffer_load_dwordx4 v[112:115], v3, s[28:31], s54 offen sc1
  s_add_u32 s52, s52, 1
  s_cmp_eq_u32 s52, 12
  s_cselect_b32 s52, 0, s52
  v_lshlrev_b32 v5, 3, v8
  v_lshl_add_u32 v5, v9, 10, v5
  s_lshl_b32 s38, s32, 16
  s_add_u32 s38, s38, s49
  s_add_u32 s38, s38, 14155776
  s_lshl_b32 s39, s32, 14
  s_add_u32 s39, s39, s49
  s_add_u32 s39, s39, 16252928
  s_lshl_b32 s48, s32, 6
  s_lshl_b32 s49, s50, 4
  s_add_u32 s48, s48, s49
  v_add_u32 v6, s48, v8
  v_mul_u32_u24 v6, 1280, v6
  v_mul_u32_u24 v7, 40, v9
  v_add_u32 v6, v6, v7
  s_mul_i32 s48, s33, 160
  v_add_u32 v6, s48, v6
  s_mov_b32 s40, s4
  s_and_b32 s41, s5, 0xffff
  s_mov_b32 s42, 2621440
  s_mov_b32 s43, 0x20000
  s_mov_b32 s56, s18
  s_and_b32 s57, s19, 0xffff
  s_mov_b32 s58, 2621440
  s_mov_b32 s59, 0x20000
  s_lshl_b32 s48, s32, 7
  s_add_u32 s34, s48, 19685376
  v_add_u32 v10, s53, v2
  s_waitcnt vmcnt(10)
  s_mov_b32 s68, 0
L_ph_r_14:
  v_xor_b32 v8, s75, v1
  v_cmp_ne_u32 vcc, 0, v8
  s_cbranch_vccz L_ph_ok_15
  s_add_u32 s68, s68, 1
  s_cmp_ge_u32 s68, 30000
  s_cbranch_scc1 L_ph_ok_15
  s_sleep 4
  buffer_load_dword v1, v11, s[28:31], s35 offen sc1
  s_waitcnt vmcnt(0)
  s_branch L_ph_r_14
L_ph_ok_15:
  s_lshl_b32 s55, s51, 14
  s_add_u32 s55, s55, s37
  s_add_u32 s51, s51, 1
  s_cmp_eq_u32 s51, 12
  s_cselect_b32 s51, 0, s51
  buffer_load_dwordx4 v[12:15], v4, s[28:31], s55 offen sc1
  buffer_load_dwordx4 v[16:19], v4, s[28:31], s55 offen offset:256 sc1
  buffer_load_dwordx4 v[20:23], v4, s[28:31], s55 offen offset:512 sc1
  buffer_load_dwordx4 v[24:27], v4, s[28:31], s55 offen offset:768 sc1
  s_lshl_b32 s55, s51, 14
  s_add_u32 s55, s55, s37
  s_add_u32 s51, s51, 1
  s_cmp_eq_u32 s51, 12
  s_cselect_b32 s51, 0, s51
  buffer_load_dwordx4 v[28:31], v4, s[28:31], s55 offen sc1
  buffer_load_dwordx4 v[32:35], v4, s[28:31], s55 offen offset:256 sc1
  buffer_load_dwordx4 v[36:39], v4, s[28:31], s55 offen offset:512 sc1
  buffer_load_dwordx4 v[40:43], v4, s[28:31], s55 offen offset:768 sc1
  s_mul_i32 s54, s52, 20480
  s_add_u32 s54, s54, s36
  buffer_load_dwordx4 v[116:119], v2, s[28:31], s54 offen sc1
  buffer_load_dwordx4 v[120:123], v2, s[28:31], s54 offen offset:1024 sc1
  buffer_load_dwordx4 v[124:127], v2, s[28:31], s54 offen offset:2048 sc1
  buffer_load_dwordx4 v[128:131], v2, s[28:31], s54 offen offset:3072 sc1
  buffer_load_dwordx4 v[132:135], v3, s[28:31], s54 offen sc1
  s_add_u32 s52, s52, 1
  s_cmp_eq_u32 s52, 12
  s_cselect_b32 s52, 0, s52
  s_lshl_b32 s55, s51, 14
  s_add_u32 s55, s55, s37
  s_add_u32 s51, s51, 1
  s_cmp_eq_u32 s51, 12
  s_cselect_b32 s51, 0, s51
  buffer_load_dwordx4 v[44:47], v4, s[28:31], s55 offen sc1
  buffer_load_dwordx4 v[48:51], v4, s[28:31], s55 offen offset:256 sc1
  buffer_load_dwordx4 v[52:55], v4, s[28:31], s55 offen offset:512 sc1
  buffer_load_dwordx4 v[56:59], v4, s[28:31], s55 offen offset:768 sc1
  s_mul_i32 s54, s52, 20480
  s_add_u32 s54, s54, s36
  buffer_load_dwordx4 v[136:139], v2, s[28:31], s54 offen sc1
  buffer_load_dwordx4 v[140:143], v2, s[28:31], s54 offen offset:1024 sc1
  buffer_load_dwordx4 v[144:147], v2, s[28:31], s54 offen offset:2048 sc1
  buffer_load_dwordx4 v[148:151], v2, s[28:31], s54 offen offset:3072 sc1
  buffer_load_dwordx4 v[152:155], v3, s[28:31], s54 offen sc1
  s_add_u32 s52, s52, 1
  s_cmp_eq_u32 s52, 12
  s_cselect_b32 s52, 0, s52
  s_lshl_b32 s55, s51, 14
  s_add_u32 s55, s55, s37
  s_add_u32 s51, s51, 1
  s_cmp_eq_u32 s51, 12
  s_cselect_b32 s51, 0, s51
  buffer_load_dwordx4 v[60:63], v4, s[28:31], s55 offen sc1
  buffer_load_dwordx4 v[64:67], v4, s[28:31], s55 offen offset:256 sc1
  buffer_load_dwordx4 v[68:71], v4, s[28:31], s55 offen offset:512 sc1
  buffer_load_dwordx4 v[72:75], v4, s[28:31], s55 offen offset:768 sc1
  s_mul_i32 s54, s52, 20480
  s_add_u32 s54, s54, s36
  buffer_load_dwordx4 v[156:159], v2, s[28:31], s54 offen sc1
  buffer_load_dwordx4 v[160:163], v2, s[28:31], s54 offen offset:1024 sc1
  buffer_load_dwordx4 v[164:167], v2, s[28:31], s54 offen offset:2048 sc1
  buffer_load_dwordx4 v[168:171], v2, s[28:31], s54 offen offset:3072 sc1
  buffer_load_dwordx4 v[172:175], v3, s[28:31], s54 offen sc1
  s_add_u32 s52, s52, 1
  s_cmp_eq_u32 s52, 12
  s_cselect_b32 s52, 0, s52
  v_and_b32 v11, 31, v0
  v_lshlrev_b32 v11, 2, v11
  v_mov_b32 v176, 0
  v_mov_b32 v177, 0
  v_mov_b32 v178, 0
  v_mov_b32 v179, 0
  v_mov_b32 v180, 0
  v_mov_b32 v181, 0
  v_mov_b32 v182, 0
  v_mov_b32 v183, 0
  v_mov_b32 v184, 0
  v_mov_b32 v185, 0
  v_mov_b32 v186, 0
  v_mov_b32 v187, 0
  v_mov_b32 v188, 0
  v_mov_b32 v189, 0
  v_mov_b32 v190, 0
  v_mov_b32 v191, 0
  v_mov_b32 v192, 0
  v_mov_b32 v193, 0
  v_mov_b32 v194, 0
  v_mov_b32 v195, 0
  v_mov_b32 v196, 0
  v_mov_b32 v197, 0
  v_mov_b32 v198, 0
  v_mov_b32 v199, 0
  v_mov_b32 v200, 0
  v_mov_b32 v201, 0
  v_mov_b32 v202, 0
  v_mov_b32 v203, 0
  v_mov_b32 v204, 0
  v_mov_b32 v205, 0
  v_mov_b32 v206, 0
  v_mov_b32 v207, 0
  v_mov_b32 v208, 0
  v_mov_b32 v209, 0
  v_mov_b32 v210, 0
  v_mov_b32 v211, 0
  v_mov_b32 v212, 0
  v_mov_b32 v213, 0
  v_mov_b32 v214, 0
  v_mov_b32 v215, 0
  v_mov_b32 v216, 0
  v_mov_b32 v217, 0
  v_mov_b32 v218, 0
  v_mov_b32 v219, 0
  v_mov_b32 v220, 0
  v_mov_b32 v221, 0
  v_mov_b32 v222, 0
  v_mov_b32 v223, 0
  v_mov_b32 v224, 0
  v_mov_b32 v225, 0
  v_mov_b32 v226, 0
  v_mov_b32 v227, 0
  v_mov_b32 v228, 0
  v_mov_b32 v229, 0
  v_mov_b32 v230, 0
  v_mov_b32 v231, 0
  v_mov_b32 v232, 0
  v_mov_b32 v233, 0
  v_mov_b32 v234, 0
  v_mov_b32 v235, 0
  v_mov_b32 v236, 0
  v_mov_b32 v237, 0
  v_mov_b32 v238, 0
  v_mov_b32 v239, 0
  v_mov_b32 v240, 0
  v_mov_b32 v241, 0
  v_mov_b32 v242, 0
  v_mov_b32 v243, 0
  v_mov_b32 v244, 0
  v_mov_b32 v245, 0
  v_mov_b32 v246, 0
  v_mov_b32 v247, 0
  v_mov_b32 v248, 0
  v_mov_b32 v249, 0
  v_mov_b32 v250, 0
  v_mov_b32 v251, 0
  v_mov_b32 v252, 0
  v_mov_b32 v253, 0
  v_mov_b32 v254, 0
  v_mov_b32 v255, 0
  v_mov_b32 v8, 155164
  s_mov_b32 s48, 0
L_wat_w_16:
  ds_read_b32 v9, v8
  s_waitcnt lgkmcnt(0)
  v_readfirstlane_b32 s49, v9
  s_cmp_ge_u32 s49, 4
  s_cbranch_scc1 L_wat_g_17
  s_add_u32 s48, s48, 1
  s_cmp_ge_u32 s48, 1200000
  s_cbranch_scc1 L_wat_g_17
  s_sleep 2
  s_branch L_wat_w_16
L_wat_g_17:
  s_waitcnt vmcnt(27)
  v_mfma_f32_16x16x32_bf16 v[176:179], v[76:79], v[12:15], v[176:179]
  v_mfma_f32_16x16x32_bf16 v[180:183], v[76:79], v[16:19], v[180:183]
  v_mfma_f32_16x16x32_bf16 v[184:187], v[76:79], v[20:23], v[184:187]
  v_mfma_f32_16x16x32_bf16 v[188:191], v[76:79], v[24:27], v[188:191]
  v_mfma_f32_16x16x32_bf16 v[192:195], v[80:83], v[12:15], v[192:195]
  v_mfma_f32_16x16x32_bf16 v[196:199], v[80:83], v[16:19], v[196:199]
  v_mfma_f32_16x16x32_bf16 v[200:203], v[80:83], v[20:23], v[200:203]
  v_mfma_f32_16x16x32_bf16 v[204:207], v[80:83], v[24:27], v[204:207]
  v_mfma_f32_16x16x32_bf16 v[208:211], v[84:87], v[12:15], v[208:211]
  v_mfma_f32_16x16x32_bf16 v[212:215], v[84:87], v[16:19], v[212:215]
  v_mfma_f32_16x16x32_bf16 v[216:219], v[84:87], v[20:23], v[216:219]
  v_mfma_f32_16x16x32_bf16 v[220:223], v[84:87], v[24:27], v[220:223]
  v_mfma_f32_16x16x32_bf16 v[224:227], v[88:91], v[12:15], v[224:227]
  v_mfma_f32_16x16x32_bf16 v[228:231], v[88:91], v[16:19], v[228:231]
  v_mfma_f32_16x16x32_bf16 v[232:235], v[88:91], v[20:23], v[232:235]
  v_mfma_f32_16x16x32_bf16 v[236:239], v[88:91], v[24:27], v[236:239]
  v_mfma_f32_16x16x32_bf16 v[240:243], v[92:95], v[12:15], v[240:243]
  v_mfma_f32_16x16x32_bf16 v[244:247], v[92:95], v[16:19], v[244:247]
  v_mfma_f32_16x16x32_bf16 v[248:251], v[92:95], v[20:23], v[248:251]
  v_mfma_f32_16x16x32_bf16 v[252:255], v[92:95], v[24:27], v[252:255]
  s_waitcnt vmcnt(23)
  v_mfma_f32_16x16x32_bf16 v[176:179], v[96:99], v[28:31], v[176:179]
  s_lshl_b32 s55, s51, 14
  s_add_u32 s55, s55, s37
  s_add_u32 s51, s51, 1
  s_cmp_eq_u32 s51, 12
  s_cselect_b32 s51, 0, s51
  buffer_load_dwordx4 v[12:15], v4, s[28:31], s55 offen sc1
  v_mfma_f32_16x16x32_bf16 v[180:183], v[96:99], v[32:35], v[180:183]
  v_mfma_f32_16x16x32_bf16 v[184:187], v[96:99], v[36:39], v[184:187]
  buffer_load_dwordx4 v[16:19], v4, s[28:31], s55 offen offset:256 sc1
  v_mfma_f32_16x16x32_bf16 v[188:191], v[96:99], v[40:43], v[188:191]
  v_mfma_f32_16x16x32_bf16 v[192:195], v[100:103], v[28:31], v[192:195]
  buffer_load_dwordx4 v[20:23], v4, s[28:31], s55 offen offset:512 sc1
  v_mfma_f32_16x16x32_bf16 v[196:199], v[100:103], v[32:35], v[196:199]
  v_mfma_f32_16x16x32_bf16 v[200:203], v[100:103], v[36:39], v[200:203]
  buffer_load_dwordx4 v[24:27], v4, s[28:31], s55 offen offset:768 sc1
  v_mfma_f32_16x16x32_bf16 v[204:207], v[100:103], v[40:43], v[204:207]
  v_mfma_f32_16x16x32_bf16 v[208:211], v[104:107], v[28:31], v[208:211]
  s_mul_i32 s54, s52, 20480
  s_add_u32 s54, s54, s36
  buffer_load_dwordx4 v[76:79], v2, s[28:31], s54 offen sc1
  v_mfma_f32_16x16x32_bf16 v[212:215], v[104:107], v[32:35], v[212:215]
  v_mfma_f32_16x16x32_bf16 v[216:219], v[104:107], v[36:39], v[216:219]
  buffer_load_dwordx4 v[80:83], v2, s[28:31], s54 offen offset:1024 sc1
  v_mfma_f32_16x16x32_bf16 v[220:223], v[104:107], v[40:43], v[220:223]
  v_mfma_f32_16x16x32_bf16 v[224:227], v[108:111], v[28:31], v[224:227]
  buffer_load_dwordx4 v[84:87], v2, s[28:31], s54 offen offset:2048 sc1
  v_mfma_f32_16x16x32_bf16 v[228:231], v[108:111], v[32:35], v[228:231]
  v_mfma_f32_16x16x32_bf16 v[232:235], v[108:111], v[36:39], v[232:235]
  buffer_load_dwordx4 v[88:91], v2, s[28:31], s54 offen offset:3072 sc1
  v_mfma_f32_16x16x32_bf16 v[236:239], v[108:111], v[40:43], v[236:239]
  v_mfma_f32_16x16x32_bf16 v[240:243], v[112:115], v[28:31], v[240:243]
  buffer_load_dwordx4 v[92:95], v3, s[28:31], s54 offen sc1
  s_add_u32 s52, s52, 1
  s_cmp_eq_u32 s52, 12
  s_cselect_b32 s52, 0, s52
  v_mfma_f32_16x16x32_bf16 v[244:247], v[112:115], v[32:35], v[244:247]
  v_mfma_f32_16x16x32_bf16 v[248:251], v[112:115], v[36:39], v[248:251]
  v_mfma_f32_16x16x32_bf16 v[252:255], v[112:115], v[40:43], v[252:255]
  s_waitcnt vmcnt(23)
  v_mfma_f32_16x16x32_bf16 v[176:179], v[116:119], v[44:47], v[176:179]
  s_lshl_b32 s55, s51, 14
  s_add_u32 s55, s55, s37
  s_add_u32 s51, s51, 1
  s_cmp_eq_u32 s51, 12
  s_cselect_b32 s51, 0, s51
  buffer_load_dwordx4 v[28:31], v4, s[28:31], s55 offen sc1
  v_mfma_f32_16x16x32_bf16 v[180:183], v[116:119], v[48:51], v[180:183]
  v_mfma_f32_16x16x32_bf16 v[184:187], v[116:119], v[52:55], v[184:187]
  buffer_load_dwordx4 v[32:35], v4, s[28:31], s55 offen offset:256 sc1
  v_mfma_f32_16x16x32_bf16 v[188:191], v[116:119], v[56:59], v[188:191]
  v_mfma_f32_16x16x32_bf16 v[192:195], v[120:123], v[44:47], v[192:195]
  buffer_load_dwordx4 v[36:39], v4, s[28:31], s55 offen offset:512 sc1
  v_mfma_f32_16x16x32_bf16 v[196:199], v[120:123], v[48:51], v[196:199]
  v_mfma_f32_16x16x32_bf16 v[200:203], v[120:123], v[52:55], v[200:203]
  buffer_load_dwordx4 v[40:43], v4, s[28:31], s55 offen offset:768 sc1
  v_mfma_f32_16x16x32_bf16 v[204:207], v[120:123], v[56:59], v[204:207]
  v_mfma_f32_16x16x32_bf16 v[208:211], v[124:127], v[44:47], v[208:211]
  s_mul_i32 s54, s52, 20480
  s_add_u32 s54, s54, s36
  buffer_load_dwordx4 v[96:99], v2, s[28:31], s54 offen sc1
  v_mfma_f32_16x16x32_bf16 v[212:215], v[124:127], v[48:51], v[212:215]
  v_mfma_f32_16x16x32_bf16 v[216:219], v[124:127], v[52:55], v[216:219]
  buffer_load_dwordx4 v[100:103], v2, s[28:31], s54 offen offset:1024 sc1
  v_mfma_f32_16x16x32_bf16 v[220:223], v[124:127], v[56:59], v[220:223]
  v_mfma_f32_16x16x32_bf16 v[224:227], v[128:131], v[44:47], v[224:227]
  buffer_load_dwordx4 v[104:107], v2, s[28:31], s54 offen offset:2048 sc1
  v_mfma_f32_16x16x32_bf16 v[228:231], v[128:131], v[48:51], v[228:231]
  v_mfma_f32_16x16x32_bf16 v[232:235], v[128:131], v[52:55], v[232:235]
  buffer_load_dwordx4 v[108:111], v2, s[28:31], s54 offen offset:3072 sc1
  v_mfma_f32_16x16x32_bf16 v[236:239], v[128:131], v[56:59], v[236:239]
  v_mfma_f32_16x16x32_bf16 v[240:243], v[132:135], v[44:47], v[240:243]
  buffer_load_dwordx4 v[112:115], v3, s[28:31], s54 offen sc1
  s_add_u32 s52, s52, 1
  s_cmp_eq_u32 s52, 12
  s_cselect_b32 s52, 0, s52
  v_mfma_f32_16x16x32_bf16 v[244:247], v[132:135], v[48:51], v[244:247]
  v_mfma_f32_16x16x32_bf16 v[248:251], v[132:135], v[52:55], v[248:251]
  v_mfma_f32_16x16x32_bf16 v[252:255], v[132:135], v[56:59], v[252:255]
  s_waitcnt vmcnt(23)
  v_mfma_f32_16x16x32_bf16 v[176:179], v[136:139], v[60:63], v[176:179]
  s_lshl_b32 s55, s51, 14
  s_add_u32 s55, s55, s37
  s_add_u32 s51, s51, 1
  s_cmp_eq_u32 s51, 12
  s_cselect_b32 s51, 0, s51
  buffer_load_dwordx4 v[44:47], v4, s[28:31], s55 offen sc1
  v_mfma_f32_16x16x32_bf16 v[180:183], v[136:139], v[64:67], v[180:183]
  v_mfma_f32_16x16x32_bf16 v[184:187], v[136:139], v[68:71], v[184:187]
  buffer_load_dwordx4 v[48:51], v4, s[28:31], s55 offen offset:256 sc1
  v_mfma_f32_16x16x32_bf16 v[188:191], v[136:139], v[72:75], v[188:191]
  v_mfma_f32_16x16x32_bf16 v[192:195], v[140:143], v[60:63], v[192:195]
  buffer_load_dwordx4 v[52:55], v4, s[28:31], s55 offen offset:512 sc1
  v_mfma_f32_16x16x32_bf16 v[196:199], v[140:143], v[64:67], v[196:199]
  v_mfma_f32_16x16x32_bf16 v[200:203], v[140:143], v[68:71], v[200:203]
  buffer_load_dwordx4 v[56:59], v4, s[28:31], s55 offen offset:768 sc1
  v_mfma_f32_16x16x32_bf16 v[204:207], v[140:143], v[72:75], v[204:207]
  v_mfma_f32_16x16x32_bf16 v[208:211], v[144:147], v[60:63], v[208:211]
  s_mul_i32 s54, s52, 20480
  s_add_u32 s54, s54, s36
  buffer_load_dwordx4 v[116:119], v2, s[28:31], s54 offen sc1
  v_mfma_f32_16x16x32_bf16 v[212:215], v[144:147], v[64:67], v[212:215]
  v_mfma_f32_16x16x32_bf16 v[216:219], v[144:147], v[68:71], v[216:219]
  buffer_load_dwordx4 v[120:123], v2, s[28:31], s54 offen offset:1024 sc1
  v_mfma_f32_16x16x32_bf16 v[220:223], v[144:147], v[72:75], v[220:223]
  v_mfma_f32_16x16x32_bf16 v[224:227], v[148:151], v[60:63], v[224:227]
  buffer_load_dwordx4 v[124:127], v2, s[28:31], s54 offen offset:2048 sc1
  v_mfma_f32_16x16x32_bf16 v[228:231], v[148:151], v[64:67], v[228:231]
  v_mfma_f32_16x16x32_bf16 v[232:235], v[148:151], v[68:71], v[232:235]
  buffer_load_dwordx4 v[128:131], v2, s[28:31], s54 offen offset:3072 sc1
  v_mfma_f32_16x16x32_bf16 v[236:239], v[148:151], v[72:75], v[236:239]
  v_mfma_f32_16x16x32_bf16 v[240:243], v[152:155], v[60:63], v[240:243]
  buffer_load_dwordx4 v[132:135], v3, s[28:31], s54 offen sc1
  s_add_u32 s52, s52, 1
  s_cmp_eq_u32 s52, 12
  s_cselect_b32 s52, 0, s52
  v_mfma_f32_16x16x32_bf16 v[244:247], v[152:155], v[64:67], v[244:247]
  v_mfma_f32_16x16x32_bf16 v[248:251], v[152:155], v[68:71], v[248:251]
  v_mfma_f32_16x16x32_bf16 v[252:255], v[152:155], v[72:75], v[252:255]
  s_waitcnt vmcnt(23)
  v_mfma_f32_16x16x32_bf16 v[176:179], v[156:159], v[12:15], v[176:179]
  s_lshl_b32 s55, s51, 14
  s_add_u32 s55, s55, s37
  s_add_u32 s51, s51, 1
  s_cmp_eq_u32 s51, 12
  s_cselect_b32 s51, 0, s51
  buffer_load_dwordx4 v[60:63], v4, s[28:31], s55 offen sc1
  v_mfma_f32_16x16x32_bf16 v[180:183], v[156:159], v[16:19], v[180:183]
  v_mfma_f32_16x16x32_bf16 v[184:187], v[156:159], v[20:23], v[184:187]
  buffer_load_dwordx4 v[64:67], v4, s[28:31], s55 offen offset:256 sc1
  v_mfma_f32_16x16x32_bf16 v[188:191], v[156:159], v[24:27], v[188:191]
  v_mfma_f32_16x16x32_bf16 v[192:195], v[160:163], v[12:15], v[192:195]
  buffer_load_dwordx4 v[68:71], v4, s[28:31], s55 offen offset:512 sc1
  v_mfma_f32_16x16x32_bf16 v[196:199], v[160:163], v[16:19], v[196:199]
  v_mfma_f32_16x16x32_bf16 v[200:203], v[160:163], v[20:23], v[200:203]
  buffer_load_dwordx4 v[72:75], v4, s[28:31], s55 offen offset:768 sc1
  v_mfma_f32_16x16x32_bf16 v[204:207], v[160:163], v[24:27], v[204:207]
  v_mfma_f32_16x16x32_bf16 v[208:211], v[164:167], v[12:15], v[208:211]
  s_mul_i32 s54, s52, 20480
  s_add_u32 s54, s54, s36
  buffer_load_dwordx4 v[136:139], v2, s[28:31], s54 offen sc1
  v_mfma_f32_16x16x32_bf16 v[212:215], v[164:167], v[16:19], v[212:215]
  v_mfma_f32_16x16x32_bf16 v[216:219], v[164:167], v[20:23], v[216:219]
  buffer_load_dwordx4 v[140:143], v2, s[28:31], s54 offen offset:1024 sc1
  v_mfma_f32_16x16x32_bf16 v[220:223], v[164:167], v[24:27], v[220:223]
  v_mfma_f32_16x16x32_bf16 v[224:227], v[168:171], v[12:15], v[224:227]
  buffer_load_dwordx4 v[144:147], v2, s[28:31], s54 offen offset:2048 sc1
  v_mfma_f32_16x16x32_bf16 v[228:231], v[168:171], v[16:19], v[228:231]
  v_mfma_f32_16x16x32_bf16 v[232:235], v[168:171], v[20:23], v[232:235]
  buffer_load_dwordx4 v[148:151], v2, s[28:31], s54 offen offset:3072 sc1
  v_mfma_f32_16x16x32_bf16 v[236:239], v[168:171], v[24:27], v[236:239]
  v_mfma_f32_16x16x32_bf16 v[240:243], v[172:175], v[12:15], v[240:243]
  buffer_load_dwordx4 v[152:155], v3, s[28:31], s54 offen sc1
  s_add_u32 s52, s52, 1
  s_cmp_eq_u32 s52, 12
  s_cselect_b32 s52, 0, s52
  v_mfma_f32_16x16x32_bf16 v[244:247], v[172:175], v[16:19], v[244:247]
  v_mfma_f32_16x16x32_bf16 v[248:251], v[172:175], v[20:23], v[248:251]
  v_mfma_f32_16x16x32_bf16 v[252:255], v[172:175], v[24:27], v[252:255]
  s_waitcnt vmcnt(23)
  v_mfma_f32_16x16x32_bf16 v[176:179], v[76:79], v[28:31], v[176:179]
  s_lshl_b32 s55, s51, 14
  s_add_u32 s55, s55, s37
  s_add_u32 s51, s51, 1
  s_cmp_eq_u32 s51, 12
  s_cselect_b32 s51, 0, s51
  buffer_load_dwordx4 v[12:15], v4, s[28:31], s55 offen sc1
  v_mfma_f32_16x16x32_bf16 v[180:183], v[76:79], v[32:35], v[180:183]
  v_mfma_f32_16x16x32_bf16 v[184:187], v[76:79], v[36:39], v[184:187]
  buffer_load_dwordx4 v[16:19], v4, s[28:31], s55 offen offset:256 sc1
  v_mfma_f32_16x16x32_bf16 v[188:191], v[76:79], v[40:43], v[188:191]
  v_mfma_f32_16x16x32_bf16 v[192:195], v[80:83], v[28:31], v[192:195]
  buffer_load_dwordx4 v[20:23], v4, s[28:31], s55 offen offset:512 sc1
  v_mfma_f32_16x16x32_bf16 v[196:199], v[80:83], v[32:35], v[196:199]
  v_mfma_f32_16x16x32_bf16 v[200:203], v[80:83], v[36:39], v[200:203]
  buffer_load_dwordx4 v[24:27], v4, s[28:31], s55 offen offset:768 sc1
  v_mfma_f32_16x16x32_bf16 v[204:207], v[80:83], v[40:43], v[204:207]
  v_mfma_f32_16x16x32_bf16 v[208:211], v[84:87], v[28:31], v[208:211]
  s_mul_i32 s54, s52, 20480
  s_add_u32 s54, s54, s36
  buffer_load_dwordx4 v[156:159], v2, s[28:31], s54 offen sc1
  v_mfma_f32_16x16x32_bf16 v[212:215], v[84:87], v[32:35], v[212:215]
  v_mfma_f32_16x16x32_bf16 v[216:219], v[84:87], v[36:39], v[216:219]
  buffer_load_dwordx4 v[160:163], v2, s[28:31], s54 offen offset:1024 sc1
  v_mfma_f32_16x16x32_bf16 v[220:223], v[84:87], v[40:43], v[220:223]
  v_mfma_f32_16x16x32_bf16 v[224:227], v[88:91], v[28:31], v[224:227]
  buffer_load_dwordx4 v[164:167], v2, s[28:31], s54 offen offset:2048 sc1
  v_mfma_f32_16x16x32_bf16 v[228:231], v[88:91], v[32:35], v[228:231]
  v_mfma_f32_16x16x32_bf16 v[232:235], v[88:91], v[36:39], v[232:235]
  buffer_load_dwordx4 v[168:171], v2, s[28:31], s54 offen offset:3072 sc1
  v_mfma_f32_16x16x32_bf16 v[236:239], v[88:91], v[40:43], v[236:239]
  v_mfma_f32_16x16x32_bf16 v[240:243], v[92:95], v[28:31], v[240:243]
  buffer_load_dwordx4 v[172:175], v3, s[28:31], s54 offen sc1
  s_add_u32 s52, s52, 1
  s_cmp_eq_u32 s52, 12
  s_cselect_b32 s52, 0, s52
  v_mfma_f32_16x16x32_bf16 v[244:247], v[92:95], v[32:35], v[244:247]
  v_mfma_f32_16x16x32_bf16 v[248:251], v[92:95], v[36:39], v[248:251]
  v_mfma_f32_16x16x32_bf16 v[252:255], v[92:95], v[40:43], v[252:255]
  s_waitcnt vmcnt(23)
  v_mfma_f32_16x16x32_bf16 v[176:179], v[96:99], v[44:47], v[176:179]
  s_lshl_b32 s55, s51, 14
  s_add_u32 s55, s55, s37
  s_add_u32 s51, s51, 1
  s_cmp_eq_u32 s51, 12
  s_cselect_b32 s51, 0, s51
  buffer_load_dwordx4 v[28:31], v4, s[28:31], s55 offen sc1
  v_mfma_f32_16x16x32_bf16 v[180:183], v[96:99], v[48:51], v[180:183]
  v_mfma_f32_16x16x32_bf16 v[184:187], v[96:99], v[52:55], v[184:187]
  buffer_load_dwordx4 v[32:35], v4, s[28:31], s55 offen offset:256 sc1
  v_mfma_f32_16x16x32_bf16 v[188:191], v[96:99], v[56:59], v[188:191]
  v_mfma_f32_16x16x32_bf16 v[192:195], v[100:103], v[44:47], v[192:195]
  buffer_load_dwordx4 v[36:39], v4, s[28:31], s55 offen offset:512 sc1
  v_mfma_f32_16x16x32_bf16 v[196:199], v[100:103], v[48:51], v[196:199]
  v_mfma_f32_16x16x32_bf16 v[200:203], v[100:103], v[52:55], v[200:203]
  buffer_load_dwordx4 v[40:43], v4, s[28:31], s55 offen offset:768 sc1
  v_mfma_f32_16x16x32_bf16 v[204:207], v[100:103], v[56:59], v[204:207]
  v_mfma_f32_16x16x32_bf16 v[208:211], v[104:107], v[44:47], v[208:211]
  s_mul_i32 s54, s52, 20480
  s_add_u32 s54, s54, s36
  buffer_load_dwordx4 v[76:79], v2, s[28:31], s54 offen sc1
  v_mfma_f32_16x16x32_bf16 v[212:215], v[104:107], v[48:51], v[212:215]
  v_mfma_f32_16x16x32_bf16 v[216:219], v[104:107], v[52:55], v[216:219]
  buffer_load_dwordx4 v[80:83], v2, s[28:31], s54 offen offset:1024 sc1
  v_mfma_f32_16x16x32_bf16 v[220:223], v[104:107], v[56:59], v[220:223]
  v_mfma_f32_16x16x32_bf16 v[224:227], v[108:111], v[44:47], v[224:227]
  buffer_load_dwordx4 v[84:87], v2, s[28:31], s54 offen offset:2048 sc1
  v_mfma_f32_16x16x32_bf16 v[228:231], v[108:111], v[48:51], v[228:231]
  v_mfma_f32_16x16x32_bf16 v[232:235], v[108:111], v[52:55], v[232:235]
  buffer_load_dwordx4 v[88:91], v2, s[28:31], s54 offen offset:3072 sc1
  v_mfma_f32_16x16x32_bf16 v[236:239], v[108:111], v[56:59], v[236:239]
  v_mfma_f32_16x16x32_bf16 v[240:243], v[112:115], v[44:47], v[240:243]
  buffer_load_dwordx4 v[92:95], v3, s[28:31], s54 offen sc1
  s_add_u32 s52, s52, 1
  s_cmp_eq_u32 s52, 12
  s_cselect_b32 s52, 0, s52
  v_mfma_f32_16x16x32_bf16 v[244:247], v[112:115], v[48:51], v[244:247]
  v_mfma_f32_16x16x32_bf16 v[248:251], v[112:115], v[52:55], v[248:251]
  v_mfma_f32_16x16x32_bf16 v[252:255], v[112:115], v[56:59], v[252:255]
  s_waitcnt vmcnt(23)
  v_mfma_f32_16x16x32_bf16 v[176:179], v[116:119], v[60:63], v[176:179]
  s_lshl_b32 s55, s51, 14
  s_add_u32 s55, s55, s37
  s_add_u32 s51, s51, 1
  s_cmp_eq_u32 s51, 12
  s_cselect_b32 s51, 0, s51
  buffer_load_dwordx4 v[44:47], v4, s[28:31], s55 offen sc1
  v_mfma_f32_16x16x32_bf16 v[180:183], v[116:119], v[64:67], v[180:183]
  v_mfma_f32_16x16x32_bf16 v[184:187], v[116:119], v[68:71], v[184:187]
  buffer_load_dwordx4 v[48:51], v4, s[28:31], s55 offen offset:256 sc1
  v_mfma_f32_16x16x32_bf16 v[188:191], v[116:119], v[72:75], v[188:191]
  v_mfma_f32_16x16x32_bf16 v[192:195], v[120:123], v[60:63], v[192:195]
  buffer_load_dwordx4 v[52:55], v4, s[28:31], s55 offen offset:512 sc1
  v_mfma_f32_16x16x32_bf16 v[196:199], v[120:123], v[64:67], v[196:199]
  v_mfma_f32_16x16x32_bf16 v[200:203], v[120:123], v[68:71], v[200:203]
  buffer_load_dwordx4 v[56:59], v4, s[28:31], s55 offen offset:768 sc1
  v_mfma_f32_16x16x32_bf16 v[204:207], v[120:123], v[72:75], v[204:207]
  v_mfma_f32_16x16x32_bf16 v[208:211], v[124:127], v[60:63], v[208:211]
  s_mul_i32 s54, s52, 20480
  s_add_u32 s54, s54, s36
  buffer_load_dwordx4 v[96:99], v2, s[28:31], s54 offen sc1
  v_mfma_f32_16x16x32_bf16 v[212:215], v[124:127], v[64:67], v[212:215]
  v_mfma_f32_16x16x32_bf16 v[216:219], v[124:127], v[68:71], v[216:219]
  buffer_load_dwordx4 v[100:103], v2, s[28:31], s54 offen offset:1024 sc1
  v_mfma_f32_16x16x32_bf16 v[220:223], v[124:127], v[72:75], v[220:223]
  v_mfma_f32_16x16x32_bf16 v[224:227], v[128:131], v[60:63], v[224:227]
  buffer_load_dwordx4 v[104:107], v2, s[28:31], s54 offen offset:2048 sc1
  v_mfma_f32_16x16x32_bf16 v[228:231], v[128:131], v[64:67], v[228:231]
  v_mfma_f32_16x16x32_bf16 v[232:235], v[128:131], v[68:71], v[232:235]
  buffer_load_dwordx4 v[108:111], v2, s[28:31], s54 offen offset:3072 sc1
  v_mfma_f32_16x16x32_bf16 v[236:239], v[128:131], v[72:75], v[236:239]
  v_mfma_f32_16x16x32_bf16 v[240:243], v[132:135], v[60:63], v[240:243]
  buffer_load_dwordx4 v[112:115], v3, s[28:31], s54 offen sc1
  s_add_u32 s52, s52, 1
  s_cmp_eq_u32 s52, 12
  s_cselect_b32 s52, 0, s52
  v_mfma_f32_16x16x32_bf16 v[244:247], v[132:135], v[64:67], v[244:247]
  v_mfma_f32_16x16x32_bf16 v[248:251], v[132:135], v[68:71], v[248:251]
  v_mfma_f32_16x16x32_bf16 v[252:255], v[132:135], v[72:75], v[252:255]
  s_waitcnt vmcnt(23)
  v_mfma_f32_16x16x32_bf16 v[176:179], v[136:139], v[12:15], v[176:179]
  s_lshl_b32 s55, s51, 14
  s_add_u32 s55, s55, s37
  s_add_u32 s51, s51, 1
  s_cmp_eq_u32 s51, 12
  s_cselect_b32 s51, 0, s51
  buffer_load_dwordx4 v[60:63], v4, s[28:31], s55 offen sc1
  v_mfma_f32_16x16x32_bf16 v[180:183], v[136:139], v[16:19], v[180:183]
  v_mfma_f32_16x16x32_bf16 v[184:187], v[136:139], v[20:23], v[184:187]
  buffer_load_dwordx4 v[64:67], v4, s[28:31], s55 offen offset:256 sc1
  v_mfma_f32_16x16x32_bf16 v[188:191], v[136:139], v[24:27], v[188:191]
  v_mfma_f32_16x16x32_bf16 v[192:195], v[140:143], v[12:15], v[192:195]
  buffer_load_dwordx4 v[68:71], v4, s[28:31], s55 offen offset:512 sc1
  v_mfma_f32_16x16x32_bf16 v[196:199], v[140:143], v[16:19], v[196:199]
  v_mfma_f32_16x16x32_bf16 v[200:203], v[140:143], v[20:23], v[200:203]
  buffer_load_dwordx4 v[72:75], v4, s[28:31], s55 offen offset:768 sc1
  v_mfma_f32_16x16x32_bf16 v[204:207], v[140:143], v[24:27], v[204:207]
  v_mfma_f32_16x16x32_bf16 v[208:211], v[144:147], v[12:15], v[208:211]
  ds_read_b128 v[116:119], v10 offset:0
  v_mfma_f32_16x16x32_bf16 v[212:215], v[144:147], v[16:19], v[212:215]
  v_mfma_f32_16x16x32_bf16 v[216:219], v[144:147], v[20:23], v[216:219]
  ds_read_b128 v[120:123], v10 offset:1024
  v_mfma_f32_16x16x32_bf16 v[220:223], v[144:147], v[24:27], v[220:223]
  v_mfma_f32_16x16x32_bf16 v[224:227], v[148:151], v[12:15], v[224:227]
  ds_read_b128 v[124:127], v10 offset:2048
  v_mfma_f32_16x16x32_bf16 v[228:231], v[148:151], v[16:19], v[228:231]
  v_mfma_f32_16x16x32_bf16 v[232:235], v[148:151], v[20:23], v[232:235]
  ds_read_b128 v[128:131], v10 offset:3072
  v_mfma_f32_16x16x32_bf16 v[236:239], v[148:151], v[24:27], v[236:239]
  v_mfma_f32_16x16x32_bf16 v[240:243], v[152:155], v[12:15], v[240:243]
  ds_read_b128 v[132:135], v10 offset:4096
  v_mfma_f32_16x16x32_bf16 v[244:247], v[152:155], v[16:19], v[244:247]
  v_mfma_f32_16x16x32_bf16 v[248:251], v[152:155], v[20:23], v[248:251]
  v_mfma_f32_16x16x32_bf16 v[252:255], v[152:155], v[24:27], v[252:255]
  s_waitcnt vmcnt(18)
  v_mfma_f32_16x16x32_bf16 v[176:179], v[156:159], v[28:31], v[176:179]
  ds_read_b128 v[136:139], v10 offset:5120
  v_mfma_f32_16x16x32_bf16 v[180:183], v[156:159], v[32:35], v[180:183]
  v_mfma_f32_16x16x32_bf16 v[184:187], v[156:159], v[36:39], v[184:187]
  ds_read_b128 v[140:143], v10 offset:6144
  v_mfma_f32_16x16x32_bf16 v[188:191], v[156:159], v[40:43], v[188:191]
  v_mfma_f32_16x16x32_bf16 v[192:195], v[160:163], v[28:31], v[192:195]
  ds_read_b128 v[144:147], v10 offset:7168
  v_mfma_f32_16x16x32_bf16 v[196:199], v[160:163], v[32:35], v[196:199]
  v_mfma_f32_16x16x32_bf16 v[200:203], v[160:163], v[36:39], v[200:203]
  ds_read_b128 v[148:151], v10 offset:8192
  v_mfma_f32_16x16x32_bf16 v[204:207], v[160:163], v[40:43], v[204:207]
  v_mfma_f32_16x16x32_bf16 v[208:211], v[164:167], v[28:31], v[208:211]
  ds_read_b128 v[152:155], v10 offset:9216
  v_mfma_f32_16x16x32_bf16 v[212:215], v[164:167], v[32:35], v[212:215]
  v_mfma_f32_16x16x32_bf16 v[216:219], v[164:167], v[36:39], v[216:219]
  v_mfma_f32_16x16x32_bf16 v[220:223], v[164:167], v[40:43], v[220:223]
  v_mfma_f32_16x16x32_bf16 v[224:227], v[168:171], v[28:31], v[224:227]
  v_mfma_f32_16x16x32_bf16 v[228:231], v[168:171], v[32:35], v[228:231]
  v_mfma_f32_16x16x32_bf16 v[232:235], v[168:171], v[36:39], v[232:235]
  v_mfma_f32_16x16x32_bf16 v[236:239], v[168:171], v[40:43], v[236:239]
  v_mfma_f32_16x16x32_bf16 v[240:243], v[172:175], v[28:31], v[240:243]
  v_mfma_f32_16x16x32_bf16 v[244:247], v[172:175], v[32:35], v[244:247]
  v_mfma_f32_16x16x32_bf16 v[248:251], v[172:175], v[36:39], v[248:251]
  v_mfma_f32_16x16x32_bf16 v[252:255], v[172:175], v[40:43], v[252:255]
  s_waitcnt vmcnt(9)
  v_mfma_f32_16x16x32_bf16 v[176:179], v[76:79], v[44:47], v[176:179]
  ds_read_b128 v[156:159], v10 offset:10240
  v_mfma_f32_16x16x32_bf16 v[180:183], v[76:79], v[48:51], v[180:183]
  v_mfma_f32_16x16x32_bf16 v[184:187], v[76:79], v[52:55], v[184:187]
  ds_read_b128 v[160:163], v10 offset:11264
  v_mfma_f32_16x16x32_bf16 v[188:191], v[76:79], v[56:59], v[188:191]
  v_mfma_f32_16x16x32_bf16 v[192:195], v[80:83], v[44:47], v[192:195]
  ds_read_b128 v[164:167], v10 offset:12288
  v_mfma_f32_16x16x32_bf16 v[196:199], v[80:83], v[48:51], v[196:199]
  v_mfma_f32_16x16x32_bf16 v[200:203], v[80:83], v[52:55], v[200:203]
  ds_read_b128 v[168:171], v10 offset:13312
  v_mfma_f32_16x16x32_bf16 v[204:207], v[80:83], v[56:59], v[204:207]
  v_mfma_f32_16x16x32_bf16 v[208:211], v[84:87], v[44:47], v[208:211]
  ds_read_b128 v[172:175], v10 offset:14336
  v_mfma_f32_16x16x32_bf16 v[212:215], v[84:87], v[48:51], v[212:215]
  v_mfma_f32_16x16x32_bf16 v[216:219], v[84:87], v[52:55], v[216:219]
  buffer_load_dword v1, v11, s[28:31], s34 offen sc1
  v_mfma_f32_16x16x32_bf16 v[220:223], v[84:87], v[56:59], v[220:223]
  v_mfma_f32_16x16x32_bf16 v[224:227], v[88:91], v[44:47], v[224:227]
  v_mfma_f32_16x16x32_bf16 v[228:231], v[88:91], v[48:51], v[228:231]
  v_mfma_f32_16x16x32_bf16 v[232:235], v[88:91], v[52:55], v[232:235]
  v_mfma_f32_16x16x32_bf16 v[236:239], v[88:91], v[56:59], v[236:239]
  v_mfma_f32_16x16x32_bf16 v[240:243], v[92:95], v[44:47], v[240:243]
  v_mfma_f32_16x16x32_bf16 v[244:247], v[92:95], v[48:51], v[244:247]
  v_mfma_f32_16x16x32_bf16 v[248:251], v[92:95], v[52:55], v[248:251]
  v_mfma_f32_16x16x32_bf16 v[252:255], v[92:95], v[56:59], v[252:255]
  s_waitcnt vmcnt(0)
  s_mov_b32 s68, 0
L_po_r_18:
  v_xor_b32 v8, s75, v1
  v_cmp_ne_u32 vcc, 0, v8
  s_cbranch_vccz L_po_ok_19
  s_add_u32 s68, s68, 1
  s_cmp_ge_u32 s68, 30000
  s_cbranch_scc1 L_po_ok_19
  s_sleep 2
  buffer_load_dword v1, v11, s[28:31], s34 offen sc1
  s_waitcnt vmcnt(0)
  s_branch L_po_r_18
L_po_ok_19:
  s_add_u32 s55, s38, 0
  buffer_load_dwordx4 v[12:15], v4, s[28:31], s55 offen sc1
  buffer_load_dwordx4 v[16:19], v4, s[28:31], s55 offen offset:256 sc1
  buffer_load_dwordx4 v[20:23], v4, s[28:31], s55 offen offset:512 sc1
  buffer_load_dwordx4 v[24:27], v4, s[28:31], s55 offen offset:768 sc1
  s_add_u32 s55, s38, 16384
  buffer_load_dwordx4 v[28:31], v4, s[28:31], s55 offen sc1
  buffer_load_dwordx4 v[32:35], v4, s[28:31], s55 offen offset:256 sc1
  buffer_load_dwordx4 v[36:39], v4, s[28:31], s55 offen offset:512 sc1
  buffer_load_dwordx4 v[40:43], v4, s[28:31], s55 offen offset:768 sc1
  v_mfma_f32_16x16x32_bf16 v[176:179], v[96:99], v[60:63], v[176:179]
  s_add_u32 s55, s38, 32768
  buffer_load_dwordx4 v[44:47], v4, s[28:31], s55 offen sc1
  v_mfma_f32_16x16x32_bf16 v[180:183], v[96:99], v[64:67], v[180:183]
  v_mfma_f32_16x16x32_bf16 v[184:187], v[96:99], v[68:71], v[184:187]
  buffer_load_dwordx4 v[48:51], v4, s[28:31], s55 offen offset:256 sc1
  v_mfma_f32_16x16x32_bf16 v[188:191], v[96:99], v[72:75], v[188:191]
  v_mfma_f32_16x16x32_bf16 v[192:195], v[100:103], v[60:63], v[192:195]
  buffer_load_dwordx4 v[52:55], v4, s[28:31], s55 offen offset:512 sc1
  v_mfma_f32_16x16x32_bf16 v[196:199], v[100:103], v[64:67], v[196:199]
  v_mfma_f32_16x16x32_bf16 v[200:203], v[100:103], v[68:71], v[200:203]
  buffer_load_dwordx4 v[56:59], v4, s[28:31], s55 offen offset:768 sc1
  v_mfma_f32_16x16x32_bf16 v[204:207], v[100:103], v[72:75], v[204:207]
  v_mfma_f32_16x16x32_bf16 v[208:211], v[104:107], v[60:63], v[208:211]
  ds_read_b128 v[76:79], v10 offset:15360
  v_mfma_f32_16x16x32_bf16 v[212:215], v[104:107], v[64:67], v[212:215]
  v_mfma_f32_16x16x32_bf16 v[216:219], v[104:107], v[68:71], v[216:219]
  ds_read_b128 v[80:83], v10 offset:16384
  v_mfma_f32_16x16x32_bf16 v[220:223], v[104:107], v[72:75], v[220:223]
  v_mfma_f32_16x16x32_bf16 v[224:227], v[108:111], v[60:63], v[224:227]
  ds_read_b128 v[84:87], v10 offset:17408
  v_mfma_f32_16x16x32_bf16 v[228:231], v[108:111], v[64:67], v[228:231]
  v_mfma_f32_16x16x32_bf16 v[232:235], v[108:111], v[68:71], v[232:235]
  ds_read_b128 v[88:91], v10 offset:18432
  v_mfma_f32_16x16x32_bf16 v[236:239], v[108:111], v[72:75], v[236:239]
  v_mfma_f32_16x16x32_bf16 v[240:243], v[112:115], v[60:63], v[240:243]
  ds_read_b128 v[92:95], v10 offset:19456
  v_mfma_f32_16x16x32_bf16 v[244:247], v[112:115], v[64:67], v[244:247]
  v_mfma_f32_16x16x32_bf16 v[248:251], v[112:115], v[68:71], v[248:251]
  v_mfma_f32_16x16x32_bf16 v[252:255], v[112:115], v[72:75], v[252:255]
  s_waitcnt vmcnt(8)
  s_waitcnt lgkmcnt(15)
  v_mfma_f32_16x16x32_bf16 v[176:179], v[116:119], v[12:15], v[176:179]
  s_add_u32 s55, s38, 49152
  buffer_load_dwordx4 v[60:63], v4, s[28:31], s55 offen sc1
  v_mfma_f32_16x16x32_bf16 v[180:183], v[116:119], v[16:19], v[180:183]
  v_mfma_f32_16x16x32_bf16 v[184:187], v[116:119], v[20:23], v[184:187]
  buffer_load_dwordx4 v[64:67], v4, s[28:31], s55 offen offset:256 sc1
  v_mfma_f32_16x16x32_bf16 v[188:191], v[116:119], v[24:27], v[188:191]
  v_mfma_f32_16x16x32_bf16 v[192:195], v[120:123], v[12:15], v[192:195]
  buffer_load_dwordx4 v[68:71], v4, s[28:31], s55 offen offset:512 sc1
  v_mfma_f32_16x16x32_bf16 v[196:199], v[120:123], v[16:19], v[196:199]
  v_mfma_f32_16x16x32_bf16 v[200:203], v[120:123], v[20:23], v[200:203]
  buffer_load_dwordx4 v[72:75], v4, s[28:31], s55 offen offset:768 sc1
  v_mfma_f32_16x16x32_bf16 v[204:207], v[120:123], v[24:27], v[204:207]
  v_mfma_f32_16x16x32_bf16 v[208:211], v[124:127], v[12:15], v[208:211]
  ds_read_b128 v[96:99], v10 offset:20480
  v_mfma_f32_16x16x32_bf16 v[212:215], v[124:127], v[16:19], v[212:215]
  v_mfma_f32_16x16x32_bf16 v[216:219], v[124:127], v[20:23], v[216:219]
  ds_read_b128 v[100:103], v10 offset:21504
  v_mfma_f32_16x16x32_bf16 v[220:223], v[124:127], v[24:27], v[220:223]
  v_mfma_f32_16x16x32_bf16 v[224:227], v[128:131], v[12:15], v[224:227]
  ds_read_b128 v[104:107], v10 offset:22528
  v_mfma_f32_16x16x32_bf16 v[228:231], v[128:131], v[16:19], v[228:231]
  v_mfma_f32_16x16x32_bf16 v[232:235], v[128:131], v[20:23], v[232:235]
  ds_read_b128 v[108:111], v10 offset:23552
  v_mfma_f32_16x16x32_bf16 v[236:239], v[128:131], v[24:27], v[236:239]
  v_mfma_f32_16x16x32_bf16 v[240:243], v[132:135], v[12:15], v[240:243]
  ds_read_b128 v[112:115], v10 offset:24576
  v_mfma_f32_16x16x32_bf16 v[244:247], v[132:135], v[16:19], v[244:247]
  v_mfma_f32_16x16x32_bf16 v[248:251], v[132:135], v[20:23], v[248:251]
  v_mfma_f32_16x16x32_bf16 v[252:255], v[132:135], v[24:27], v[252:255]
  s_waitcnt vmcnt(8)
  s_waitcnt lgkmcnt(15)
  v_mfma_f32_16x16x32_bf16 v[176:179], v[136:139], v[28:31], v[176:179]
  buffer_load_dwordx2 v[12:13], v5, s[28:31], s39 offen offset:0 sc1
  v_mfma_f32_16x16x32_bf16 v[180:183], v[136:139], v[32:35], v[180:183]
  v_mfma_f32_16x16x32_bf16 v[184:187], v[136:139], v[36:39], v[184:187]
  buffer_load_dwordx2 v[14:15], v5, s[28:31], s39 offen offset:512 sc1
  v_mfma_f32_16x16x32_bf16 v[188:191], v[136:139], v[40:43], v[188:191]
  v_mfma_f32_16x16x32_bf16 v[192:195], v[140:143], v[28:31], v[192:195]
  buffer_load_dwordx2 v[16:17], v5, s[28:31], s39 offen offset:128 sc1
  v_mfma_f32_16x16x32_bf16 v[196:199], v[140:143], v[32:35], v[196:199]
  v_mfma_f32_16x16x32_bf16 v[200:203], v[140:143], v[36:39], v[200:203]
  buffer_load_dwordx2 v[18:19], v5, s[28:31], s39 offen offset:640 sc1
  v_mfma_f32_16x16x32_bf16 v[204:207], v[140:143], v[40:43], v[204:207]
  v_mfma_f32_16x16x32_bf16 v[208:211], v[144:147], v[28:31], v[208:211]
  buffer_load_dwordx2 v[20:21], v5, s[28:31], s39 offen offset:256 sc1
  v_mfma_f32_16x16x32_bf16 v[212:215], v[144:147], v[32:35], v[212:215]
  v_mfma_f32_16x16x32_bf16 v[216:219], v[144:147], v[36:39], v[216:219]
  buffer_load_dwordx2 v[22:23], v5, s[28:31], s39 offen offset:768 sc1
  v_mfma_f32_16x16x32_bf16 v[220:223], v[144:147], v[40:43], v[220:223]
  v_mfma_f32_16x16x32_bf16 v[224:227], v[148:151], v[28:31], v[224:227]
  buffer_load_dwordx2 v[24:25], v5, s[28:31], s39 offen offset:384 sc1
  v_mfma_f32_16x16x32_bf16 v[228:231], v[148:151], v[32:35], v[228:231]
  v_mfma_f32_16x16x32_bf16 v[232:235], v[148:151], v[36:39], v[232:235]
  buffer_load_dwordx2 v[26:27], v5, s[28:31], s39 offen offset:896 sc1
  v_mfma_f32_16x16x32_bf16 v[236:239], v[148:151], v[40:43], v[236:239]
  v_mfma_f32_16x16x32_bf16 v[240:243], v[152:155], v[28:31], v[240:243]
  v_mfma_f32_16x16x32_bf16 v[244:247], v[152:155], v[32:35], v[244:247]
  v_mfma_f32_16x16x32_bf16 v[248:251], v[152:155], v[36:39], v[248:251]
  v_mfma_f32_16x16x32_bf16 v[252:255], v[152:155], v[40:43], v[252:255]
  s_waitcnt vmcnt(12)
  s_waitcnt lgkmcnt(14)
  v_mfma_f32_16x16x32_bf16 v[176:179], v[156:159], v[44:47], v[176:179]
  v_mfma_f32_16x16x32_bf16 v[180:183], v[156:159], v[48:51], v[180:183]
  v_mfma_f32_16x16x32_bf16 v[184:187], v[156:159], v[52:55], v[184:187]
  v_mfma_f32_16x16x32_bf16 v[188:191], v[156:159], v[56:59], v[188:191]
  s_waitcnt lgkmcnt(13)
  v_mfma_f32_16x16x32_bf16 v[192:195], v[160:163], v[44:47], v[192:195]
  v_mfma_f32_16x16x32_bf16 v[196:199], v[160:163], v[48:51], v[196:199]
  v_mfma_f32_16x16x32_bf16 v[200:203], v[160:163], v[52:55], v[200:203]
  v_mfma_f32_16x16x32_bf16 v[204:207], v[160:163], v[56:59], v[204:207]
  s_waitcnt lgkmcnt(12)
  v_mfma_f32_16x16x32_bf16 v[208:211], v[164:167], v[44:47], v[208:211]
  v_mfma_f32_16x16x32_bf16 v[212:215], v[164:167], v[48:51], v[212:215]
  v_mfma_f32_16x16x32_bf16 v[216:219], v[164:167], v[52:55], v[216:219]
  v_mfma_f32_16x16x32_bf16 v[220:223], v[164:167], v[56:59], v[220:223]
  s_waitcnt lgkmcnt(11)
  v_mfma_f32_16x16x32_bf16 v[224:227], v[168:171], v[44:47], v[224:227]
  v_mfma_f32_16x16x32_bf16 v[228:231], v[168:171], v[48:51], v[228:231]
  v_mfma_f32_16x16x32_bf16 v[232:235], v[168:171], v[52:55], v[232:235]
  v_mfma_f32_16x16x32_bf16 v[236:239], v[168:171], v[56:59], v[236:239]
  s_waitcnt lgkmcnt(10)
  v_mfma_f32_16x16x32_bf16 v[240:243], v[172:175], v[44:47], v[240:243]
  v_mfma_f32_16x16x32_bf16 v[244:247], v[172:175], v[48:51], v[244:247]
  v_mfma_f32_16x16x32_bf16 v[248:251], v[172:175], v[52:55], v[248:251]
  v_mfma_f32_16x16x32_bf16 v[252:255], v[172:175], v[56:59], v[252:255]
  s_waitcnt vmcnt(8)
  s_waitcnt lgkmcnt(9)
  v_mfma_f32_16x16x32_bf16 v[176:179], v[76:79], v[60:63], v[176:179]
  buffer_load_dwordx4 v[28:31], v6, s[40:43], 0 offen
  buffer_load_dwordx4 v[32:35], v6, s[40:43], 0 offen offset:16
  buffer_load_dwordx2 v[36:37], v6, s[40:43], 0 offen offset:32
  v_mfma_f32_16x16x32_bf16 v[180:183], v[76:79], v[64:67], v[180:183]
  v_mfma_f32_16x16x32_bf16 v[184:187], v[76:79], v[68:71], v[184:187]
  v_mfma_f32_16x16x32_bf16 v[188:191], v[76:79], v[72:75], v[188:191]
  s_waitcnt lgkmcnt(8)
  v_mfma_f32_16x16x32_bf16 v[192:195], v[80:83], v[60:63], v[192:195]
  v_mfma_f32_16x16x32_bf16 v[196:199], v[80:83], v[64:67], v[196:199]
  v_mfma_f32_16x16x32_bf16 v[200:203], v[80:83], v[68:71], v[200:203]
  v_mfma_f32_16x16x32_bf16 v[204:207], v[80:83], v[72:75], v[204:207]
  s_waitcnt lgkmcnt(7)
  v_mfma_f32_16x16x32_bf16 v[208:211], v[84:87], v[60:63], v[208:211]
  v_mfma_f32_16x16x32_bf16 v[212:215], v[84:87], v[64:67], v[212:215]
  v_mfma_f32_16x16x32_bf16 v[216:219], v[84:87], v[68:71], v[216:219]
  v_mfma_f32_16x16x32_bf16 v[220:223], v[84:87], v[72:75], v[220:223]
  s_waitcnt lgkmcnt(6)
  v_mfma_f32_16x16x32_bf16 v[224:227], v[88:91], v[60:63], v[224:227]
  v_mfma_f32_16x16x32_bf16 v[228:231], v[88:91], v[64:67], v[228:231]
  v_mfma_f32_16x16x32_bf16 v[232:235], v[88:91], v[68:71], v[232:235]
  v_mfma_f32_16x16x32_bf16 v[236:239], v[88:91], v[72:75], v[236:239]
  s_waitcnt lgkmcnt(5)
  v_mfma_f32_16x16x32_bf16 v[240:243], v[92:95], v[60:63], v[240:243]
  v_mfma_f32_16x16x32_bf16 v[244:247], v[92:95], v[64:67], v[244:247]
  v_mfma_f32_16x16x32_bf16 v[248:251], v[92:95], v[68:71], v[248:251]
  v_mfma_f32_16x16x32_bf16 v[252:255], v[92:95], v[72:75], v[252:255]
  s_waitcnt vmcnt(3)
  s_waitcnt lgkmcnt(4)
  v_mfma_f32_16x16x32_bf16 v[176:179], v[96:99], v[12:15], v[176:179]
  v_mfma_f32_16x16x32_bf16 v[180:183], v[96:99], v[16:19], v[180:183]
  v_mfma_f32_16x16x32_bf16 v[184:187], v[96:99], v[20:23], v[184:187]
  v_mfma_f32_16x16x32_bf16 v[188:191], v[96:99], v[24:27], v[188:191]
  s_waitcnt lgkmcnt(3)
  v_mfma_f32_16x16x32_bf16 v[192:195], v[100:103], v[12:15], v[192:195]
  v_mfma_f32_16x16x32_bf16 v[196:199], v[100:103], v[16:19], v[196:199]
  v_mfma_f32_16x16x32_bf16 v[200:203], v[100:103], v[20:23], v[200:203]
  v_mfma_f32_16x16x32_bf16 v[204:207], v[100:103], v[24:27], v[204:207]
  s_waitcnt lgkmcnt(2)
  v_mfma_f32_16x16x32_bf16 v[208:211], v[104:107], v[12:15], v[208:211]
  v_mfma_f32_16x16x32_bf16 v[212:215], v[104:107], v[16:19], v[212:215]
  v_mfma_f32_16x16x32_bf16 v[216:219], v[104:107], v[20:23], v[216:219]
  v_mfma_f32_16x16x32_bf16 v[220:223], v[104:107], v[24:27], v[220:223]
  s_waitcnt lgkmcnt(1)
  v_mfma_f32_16x16x32_bf16 v[224:227], v[108:111], v[12:15], v[224:227]
  v_mfma_f32_16x16x32_bf16 v[228:231], v[108:111], v[16:19], v[228:231]
  v_mfma_f32_16x16x32_bf16 v[232:235], v[108:111], v[20:23], v[232:235]
  v_mfma_f32_16x16x32_bf16 v[236:239], v[108:111], v[24:27], v[236:239]
  s_waitcnt lgkmcnt(0)
  v_mfma_f32_16x16x32_bf16 v[240:243], v[112:115], v[12:15], v[240:243]
  v_mfma_f32_16x16x32_bf16 v[244:247], v[112:115], v[16:19], v[244:247]
  v_mfma_f32_16x16x32_bf16 v[248:251], v[112:115], v[20:23], v[248:251]
  v_mfma_f32_16x16x32_bf16 v[252:255], v[112:115], v[24:27], v[252:255]
  s_waitcnt vmcnt(0)
  s_nop 7
  s_cmp_eq_u32 s50, 0
  s_cbranch_scc1 L_red_20
  s_sub_u32 s48, 3, s50
  s_and_b32 s48, s48, 3
  s_mul_i32 s48, s48, 5120
  v_add_u32 v13, s48, v10
  ds_write_b128 v13, v[176:179] offset:0
  ds_write_b128 v13, v[192:195] offset:1024
  ds_write_b128 v13, v[208:211] offset:2048
  ds_write_b128 v13, v[224:227] offset:3072
  ds_write_b128 v13, v[240:243] offset:4096
  s_branch L_redd_21
L_red_20:
  v_lshlrev_b32 v38, 16, v28
  v_and_b32 v39, 0xffff0000, v28
  v_add_f32 v64, v176, v38
  v_add_f32 v65, v177, v39
  v_lshlrev_b32 v38, 16, v29
  v_and_b32 v39, 0xffff0000, v29
  v_add_f32 v66, v178, v38
  v_add_f32 v67, v179, v39
  v_lshlrev_b32 v38, 16, v30
  v_and_b32 v39, 0xffff0000, v30
  v_add_f32 v68, v192, v38
  v_add_f32 v69, v193, v39
  v_lshlrev_b32 v38, 16, v31
  v_and_b32 v39, 0xffff0000, v31
  v_add_f32 v70, v194, v38
  v_add_f32 v71, v195, v39
  v_lshlrev_b32 v38, 16, v32
  v_and_b32 v39, 0xffff0000, v32
  v_add_f32 v72, v208, v38
  v_add_f32 v73, v209, v39
  v_lshlrev_b32 v38, 16, v33
  v_and_b32 v39, 0xffff0000, v33
  v_add_f32 v74, v210, v38
  v_add_f32 v75, v211, v39
  v_lshlrev_b32 v38, 16, v34
  v_and_b32 v39, 0xffff0000, v34
  v_add_f32 v76, v224, v38
  v_add_f32 v77, v225, v39
  v_lshlrev_b32 v38, 16, v35
  v_and_b32 v39, 0xffff0000, v35
  v_add_f32 v78, v226, v38
  v_add_f32 v79, v227, v39
  v_lshlrev_b32 v38, 16, v36
  v_and_b32 v39, 0xffff0000, v36
  v_add_f32 v80, v240, v38
  v_add_f32 v81, v241, v39
  v_lshlrev_b32 v38, 16, v37
  v_and_b32 v39, 0xffff0000, v37
  v_add_f32 v82, v242, v38
  v_add_f32 v83, v243, v39
L_redd_21:
  s_cmp_eq_u32 s50, 1
  s_cbranch_scc1 L_red_22
  s_sub_u32 s48, 4, s50
  s_and_b32 s48, s48, 3
  s_mul_i32 s48, s48, 5120
  v_add_u32 v13, s48, v10
  ds_write_b128 v13, v[180:183] offset:0
  ds_write_b128 v13, v[196:199] offset:1024
  ds_write_b128 v13, v[212:215] offset:2048
  ds_write_b128 v13, v[228:231] offset:3072
  ds_write_b128 v13, v[244:247] offset:4096
  s_branch L_redd_23
L_red_22:
  v_lshlrev_b32 v38, 16, v28
  v_and_b32 v39, 0xffff0000, v28
  v_add_f32 v64, v180, v38
  v_add_f32 v65, v181, v39
  v_lshlrev_b32 v38, 16, v29
  v_and_b32 v39, 0xffff0000, v29
  v_add_f32 v66, v182, v38
  v_add_f32 v67, v183, v39
  v_lshlrev_b32 v38, 16, v30
  v_and_b32 v39, 0xffff0000, v30
  v_add_f32 v68, v196, v38
  v_add_f32 v69, v197, v39
  v_lshlrev_b32 v38, 16, v31
  v_and_b32 v39, 0xffff0000, v31
  v_add_f32 v70, v198, v38
  v_add_f32 v71, v199, v39
  v_lshlrev_b32 v38, 16, v32
  v_and_b32 v39, 0xffff0000, v32
  v_add_f32 v72, v212, v38
  v_add_f32 v73, v213, v39
  v_lshlrev_b32 v38, 16, v33
  v_and_b32 v39, 0xffff0000, v33
  v_add_f32 v74, v214, v38
  v_add_f32 v75, v215, v39
  v_lshlrev_b32 v38, 16, v34
  v_and_b32 v39, 0xffff0000, v34
  v_add_f32 v76, v228, v38
  v_add_f32 v77, v229, v39
  v_lshlrev_b32 v38, 16, v35
  v_and_b32 v39, 0xffff0000, v35
  v_add_f32 v78, v230, v38
  v_add_f32 v79, v231, v39
  v_lshlrev_b32 v38, 16, v36
  v_and_b32 v39, 0xffff0000, v36
  v_add_f32 v80, v244, v38
  v_add_f32 v81, v245, v39
  v_lshlrev_b32 v38, 16, v37
  v_and_b32 v39, 0xffff0000, v37
  v_add_f32 v82, v246, v38
  v_add_f32 v83, v247, v39
L_redd_23:
  s_cmp_eq_u32 s50, 2
  s_cbranch_scc1 L_red_24
  s_sub_u32 s48, 5, s50
  s_and_b32 s48, s48, 3
  s_mul_i32 s48, s48, 5120
  v_add_u32 v13, s48, v10
  ds_write_b128 v13, v[184:187] offset:0
  ds_write_b128 v13, v[200:203] offset:1024
  ds_write_b128 v13, v[216:219] offset:2048
  ds_write_b128 v13, v[232:235] offset:3072
  ds_write_b128 v13, v[248:251] offset:4096
  s_branch L_redd_25
L_red_24:
  v_lshlrev_b32 v38, 16, v28
  v_and_b32 v39, 0xffff0000, v28
  v_add_f32 v64, v184, v38
  v_add_f32 v65, v185, v39
  v_lshlrev_b32 v38, 16, v29
  v_and_b32 v39, 0xffff0000, v29
  v_add_f32 v66, v186, v38
  v_add_f32 v67, v187, v39
  v_lshlrev_b32 v38, 16, v30
  v_and_b32 v39, 0xffff0000, v30
  v_add_f32 v68, v200, v38
  v_add_f32 v69, v201, v39
  v_lshlrev_b32 v38, 16, v31
  v_and_b32 v39, 0xffff0000, v31
  v_add_f32 v70, v202, v38
  v_add_f32 v71, v203, v39
  v_lshlrev_b32 v38, 16, v32
  v_and_b32 v39, 0xffff0000, v32
  v_add_f32 v72, v216, v38
  v_add_f32 v73, v217, v39
  v_lshlrev_b32 v38, 16, v33
  v_and_b32 v39, 0xffff0000, v33
  v_add_f32 v74, v218, v38
  v_add_f32 v75, v219, v39
  v_lshlrev_b32 v38, 16, v34
  v_and_b32 v39, 0xffff0000, v34
  v_add_f32 v76, v232, v38
  v_add_f32 v77, v233, v39
  v_lshlrev_b32 v38, 16, v35
  v_and_b32 v39, 0xffff0000, v35
  v_add_f32 v78, v234, v38
  v_add_f32 v79, v235, v39
  v_lshlrev_b32 v38, 16, v36
  v_and_b32 v39, 0xffff0000, v36
  v_add_f32 v80, v248, v38
  v_add_f32 v81, v249, v39
  v_lshlrev_b32 v38, 16, v37
  v_and_b32 v39, 0xffff0000, v37
  v_add_f32 v82, v250, v38
  v_add_f32 v83, v251, v39
L_redd_25:
  s_cmp_eq_u32 s50, 3
  s_cbranch_scc1 L_red_26
  s_sub_u32 s48, 6, s50
  s_and_b32 s48, s48, 3
  s_mul_i32 s48, s48, 5120
  v_add_u32 v13, s48, v10
  ds_write_b128 v13, v[188:191] offset:0
  ds_write_b128 v13, v[204:207] offset:1024
  ds_write_b128 v13, v[220:223] offset:2048
  ds_write_b128 v13, v[236:239] offset:3072
  ds_write_b128 v13, v[252:255] offset:4096
  s_branch L_redd_27
L_red_26:
  v_lshlrev_b32 v38, 16, v28
  v_and_b32 v39, 0xffff0000, v28
  v_add_f32 v64, v188, v38
  v_add_f32 v65, v189, v39
  v_lshlrev_b32 v38, 16, v29
  v_and_b32 v39, 0xffff0000, v29
  v_add_f32 v66, v190, v38
  v_add_f32 v67, v191, v39
  v_lshlrev_b32 v38, 16, v30
  v_and_b32 v39, 0xffff0000, v30
  v_add_f32 v68, v204, v38
  v_add_f32 v69, v205, v39
  v_lshlrev_b32 v38, 16, v31
  v_and_b32 v39, 0xffff0000, v31
  v_add_f32 v70, v206, v38
  v_add_f32 v71, v207, v39
  v_lshlrev_b32 v38, 16, v32
  v_and_b32 v39, 0xffff0000, v32
  v_add_f32 v72, v220, v38
  v_add_f32 v73, v221, v39
  v_lshlrev_b32 v38, 16, v33
  v_and_b32 v39, 0xffff0000, v33
  v_add_f32 v74, v222, v38
  v_add_f32 v75, v223, v39
  v_lshlrev_b32 v38, 16, v34
  v_and_b32 v39, 0xffff0000, v34
  v_add_f32 v76, v236, v38
  v_add_f32 v77, v237, v39
  v_lshlrev_b32 v38, 16, v35
  v_and_b32 v39, 0xffff0000, v35
  v_add_f32 v78, v238, v38
  v_add_f32 v79, v239, v39
  v_lshlrev_b32 v38, 16, v36
  v_and_b32 v39, 0xffff0000, v36
  v_add_f32 v80, v252, v38
  v_add_f32 v81, v253, v39
  v_lshlrev_b32 v38, 16, v37
  v_and_b32 v39, 0xffff0000, v37
  v_add_f32 v82, v254, v38
  v_add_f32 v83, v255, v39
L_redd_27:
  s_waitcnt lgkmcnt(0)
  s_barrier
  s_sub_u32 s48, s50, 1
  s_and_b32 s48, s48, 3
  s_mul_i32 s48, s48, 25600
  s_add_u32 s48, s48, 49408
  v_add_u32 v13, s48, v2
  ds_read_b128 v[96:99], v13 offset:0
  ds_read_b128 v[100:103], v13 offset:1024
  ds_read_b128 v[104:107], v13 offset:2048
  ds_read_b128 v[108:111], v13 offset:3072
  ds_read_b128 v[112:115], v13 offset:4096
  s_sub_u32 s48, s50, 2
  s_and_b32 s48, s48, 3
  s_mul_i32 s48, s48, 25600
  s_add_u32 s48, s48, 54528
  v_add_u32 v14, s48, v2
  ds_read_b128 v[116:119], v14 offset:0
  ds_read_b128 v[120:123], v14 offset:1024
  ds_read_b128 v[124:127], v14 offset:2048
  ds_read_b128 v[128:131], v14 offset:3072
  ds_read_b128 v[132:135], v14 offset:4096
  s_sub_u32 s48, s50, 3
  s_and_b32 s48, s48, 3
  s_mul_i32 s48, s48, 25600
  s_add_u32 s48, s48, 59648
  v_add_u32 v15, s48, v2
  ds_read_b128 v[136:139], v15 offset:0
  ds_read_b128 v[140:143], v15 offset:1024
  ds_read_b128 v[144:147], v15 offset:2048
  ds_read_b128 v[148:151], v15 offset:3072
  ds_read_b128 v[152:155], v15 offset:4096
  s_waitcnt lgkmcnt(14)
  v_pk_add_f32 v[64:65], v[64:65], v[96:97]
  v_pk_add_f32 v[66:67], v[66:67], v[98:99]
  s_waitcnt lgkmcnt(13)
  v_pk_add_f32 v[68:69], v[68:69], v[100:101]
  v_pk_add_f32 v[70:71], v[70:71], v[102:103]
  s_waitcnt lgkmcnt(12)
  v_pk_add_f32 v[72:73], v[72:73], v[104:105]
  v_pk_add_f32 v[74:75], v[74:75], v[106:107]
  s_waitcnt lgkmcnt(11)
  v_pk_add_f32 v[76:77], v[76:77], v[108:109]
  v_pk_add_f32 v[78:79], v[78:79], v[110:111]
  s_waitcnt lgkmcnt(10)
  v_pk_add_f32 v[80:81], v[80:81], v[112:113]
  v_pk_add_f32 v[82:83], v[82:83], v[114:115]
  s_waitcnt lgkmcnt(9)
  v_pk_add_f32 v[64:65], v[64:65], v[116:117]
  v_pk_add_f32 v[66:67], v[66:67], v[118:119]
  s_waitcnt lgkmcnt(8)
  v_pk_add_f32 v[68:69], v[68:69], v[120:121]
  v_pk_add_f32 v[70:71], v[70:71], v[122:123]
  s_waitcnt lgkmcnt(7)
  v_pk_add_f32 v[72:73], v[72:73], v[124:125]
  v_pk_add_f32 v[74:75], v[74:75], v[126:127]
  s_waitcnt lgkmcnt(6)
  v_pk_add_f32 v[76:77], v[76:77], v[128:129]
  v_pk_add_f32 v[78:79], v[78:79], v[130:131]
  s_waitcnt lgkmcnt(5)
  v_pk_add_f32 v[80:81], v[80:81], v[132:133]
  v_pk_add_f32 v[82:83], v[82:83], v[134:135]
  s_waitcnt lgkmcnt(4)
  v_pk_add_f32 v[64:65], v[64:65], v[136:137]
  v_pk_add_f32 v[66:67], v[66:67], v[138:139]
  s_waitcnt lgkmcnt(3)
  v_pk_add_f32 v[68:69], v[68:69], v[140:141]
  v_pk_add_f32 v[70:71], v[70:71], v[142:143]
  s_waitcnt lgkmcnt(2)
  v_pk_add_f32 v[72:73], v[72:73], v[144:145]
  v_pk_add_f32 v[74:75], v[74:75], v[146:147]
  s_waitcnt lgkmcnt(1)
  v_pk_add_f32 v[76:77], v[76:77], v[148:149]
  v_pk_add_f32 v[78:79], v[78:79], v[150:151]
  s_waitcnt lgkmcnt(0)
  v_pk_add_f32 v[80:81], v[80:81], v[152:153]
  v_pk_add_f32 v[82:83], v[82:83], v[154:155]
  v_cvt_pk_bf16_f32 v64, v64, v65
  v_cvt_pk_bf16_f32 v65, v66, v67
  v_cvt_pk_bf16_f32 v66, v68, v69
  v_cvt_pk_bf16_f32 v67, v70, v71
  v_cvt_pk_bf16_f32 v68, v72, v73
  v_cvt_pk_bf16_f32 v69, v74, v75
  v_cvt_pk_bf16_f32 v70, v76, v77
  v_cvt_pk_bf16_f32 v71, v78, v79
  v_cvt_pk_bf16_f32 v72, v80, v81
  v_cvt_pk_bf16_f32 v73, v82, v83
  buffer_store_dwordx4 v[64:67], v6, s[56:59], 0 offen
  buffer_store_dwordx4 v[68:71], v6, s[56:59], 0 offen offset:16
  buffer_store_dwordx2 v[72:73], v6, s[56:59], 0 offen offset:32
  s_endpgm
L_main:
  s_and_b32 s50, s3, 1
  s_lshr_b32 s56, s3, 1
  s_lshl_b32 s52, s50, 6
  s_lshl_b32 s70, s3, 8
  s_add_u32 s70, s70, s2
  s_lshr_b32 s71, s70, 1
  s_and_b32 s72, s70, 1
  s_lshl_b32 s73, s71, 3
  s_mov_b32 s74, 4
  s_mov_b32 s76, s16
  s_mov_b32 s77, s17
  s_mov_b32 s78, 1966080
  s_cmp_lt_u32 s71, 192
  s_cbranch_scc1 L_w2set_28
  s_mov_b32 s76, s8
  s_mov_b32 s77, s9
  s_mov_b32 s78, 819200
  s_sub_u32 s48, s71, 192
  s_lshr_b32 s49, s48, 1
  s_mul_i32 s49, s49, 20
  s_and_b32 s48, s48, 1
  s_lshl_b32 s48, s48, 2
  s_add_u32 s73, s49, s48
  s_mov_b32 s74, 8
  s_cmp_lt_u32 s71, 256
  s_cbranch_scc1 L_w2set_28
  s_sub_u32 s48, s71, 256
  s_mul_i32 s48, s48, 40
  s_add_u32 s73, s48, 16
  s_mov_b32 s74, 20
L_w2set_28:
  s_and_b32 s77, s77, 0xffff
  s_mov_b32 s79, 0x20000
  s_cmp_ge_u32 s70, 544
  s_cselect_b32 s78, 0, s78
  s_mul_i32 s80, s73, 1280
  s_mul_i32 s48, s72, 640
  s_add_u32 s80, s80, s48
  v_min_u32 v13, 39, v0
  v_mul_u32_u24 v14, 52, v13
  v_lshrrev_b32 v14, 8, v14
  v_mul_u32_u24 v15, 5, v14
  v_sub_u32 v13, v13, v15
  v_lshlrev_b32 v13, 7, v13
  v_and_b32 v15, 3, v14
  v_lshrrev_b32 v14, 2, v14
  v_mul_lo_u32 v14, v14, s74
  v_add_u32 v14, v14, v15
  v_mul_u32_u24 v14, 1280, v14
  v_add_u32 v13, v13, v14
  buffer_load_dword v1, v13, s[76:79], s80 offen
  s_cmp_lg_u32 s3, 0
  s_cbranch_scc1 L_m_nononce
  s_mov_b32 s60, s20
  s_and_b32 s61, s21, 0xffff
  s_mov_b32 s62, 256
  s_mov_b32 s63, 0x20000
  v_mov_b32 v22, 0
  s_memrealtime s[48:49]
  v_lshlrev_b32 v18, 2, v0
  v_add_u32 v18, 155136, v18
  ds_write_b32 v18, v22
  s_waitcnt lgkmcnt(0)
  s_or_b32 s48, s48, 1
  v_mov_b32 v20, s48
  v_mov_b32 v21, 0
  v_mov_b32 v23, s48
  s_mov_b64 exec, 1
  buffer_atomic_cmpswap v[20:21], v22, s[60:63], 0 offen sc0 sc1
  s_mov_b64 exec, -1
L_m_nononce:
  v_and_b32 v10, 15, v0
  v_lshrrev_b32 v11, 4, v0
  v_bfe_u32 v12, v0, 1, 3
  v_add_u32 v13, s52, v10
  v_lshlrev_b32 v13, 7, v13
  v_xor_b32 v14, v11, v12
  v_lshl_add_u32 v2, v14, 4, v13
  v_xor_b32 v3, 64, v2
  v_bfe_u32 v16, v0, 2, 2
  v_lshrrev_b32 v17, 4, v0
  v_lshl_add_u32 v15, v17, 3, v16
  v_lshlrev_b32 v15, 7, v15
  v_and_b32 v18, 2, v16
  v_and_b32 v17, 1, v17
  v_or_b32 v18, v18, v17
  v_lshl_add_u32 v15, v18, 5, v15
  v_and_b32 v18, 3, v0
  v_lshl_add_u32 v15, v18, 3, v15
  v_add_u32 v15, 32768, v15
  s_lshl_b32 s48, s56, 6
  v_xor_b32 v4, s48, v15
  v_xor_b32 v5, 32, v4
  v_add_u32 v6, 65536, v4
  v_add_u32 v7, 65536, v5
  v_add_u32 v10, s52, v10
  v_lshlrev_b32 v10, 4, v10
  v_add_u32 v10, 153088, v10
  v_lshlrev_b32 v11, 4, v11
  s_lshl_b32 s48, s56, 7
  s_add_u32 s48, s48, 151808
  v_add_u32 v11, s48, v11
  v_mov_b32 v96, 0
  v_mov_b32 v97, 0
  v_mov_b32 v98, 0
  v_mov_b32 v99, 0
  v_mov_b32 v100, 0
  v_mov_b32 v101, 0
  v_mov_b32 v102, 0
  v_mov_b32 v103, 0
  v_mov_b32 v104, 0
  v_mov_b32 v105, 0
  v_mov_b32 v106, 0
  v_mov_b32 v107, 0
  v_mov_b32 v108, 0
  v_mov_b32 v109, 0
  v_mov_b32 v110, 0
  v_mov_b32 v111, 0
  v_mov_b32 v112, 0
  v_mov_b32 v113, 0
  v_mov_b32 v114, 0
  v_mov_b32 v115, 0
  v_mov_b32 v116, 0
  v_mov_b32 v117, 0
  v_mov_b32 v118, 0
  v_mov_b32 v119, 0
  v_mov_b32 v120, 0
  v_mov_b32 v121, 0
  v_mov_b32 v122, 0
  v_mov_b32 v123, 0
  v_mov_b32 v124, 0
  v_mov_b32 v125, 0
  v_mov_b32 v126, 0
  v_mov_b32 v127, 0
  v_mov_b32 v128, 0
  v_mov_b32 v129, 0
  v_mov_b32 v130, 0
  v_mov_b32 v131, 0
  v_mov_b32 v132, 0
  v_mov_b32 v133, 0
  v_mov_b32 v134, 0
  v_mov_b32 v135, 0
  v_mov_b32 v136, 0
  v_mov_b32 v137, 0
  v_mov_b32 v138, 0
  v_mov_b32 v139, 0
  v_mov_b32 v140, 0
  v_mov_b32 v141, 0
  v_mov_b32 v142, 0
  v_mov_b32 v143, 0
  v_mov_b32 v144, 0
  v_mov_b32 v145, 0
  v_mov_b32 v146, 0
  v_mov_b32 v147, 0
  v_mov_b32 v148, 0
  v_mov_b32 v149, 0
  v_mov_b32 v150, 0
  v_mov_b32 v151, 0
  v_mov_b32 v152, 0
  v_mov_b32 v153, 0
  v_mov_b32 v154, 0
  v_mov_b32 v155, 0
  v_mov_b32 v156, 0
  v_mov_b32 v157, 0
  v_mov_b32 v158, 0
  v_mov_b32 v159, 0
  v_mov_b32 v160, 0
  v_mov_b32 v161, 0
  v_mov_b32 v162, 0
  v_mov_b32 v163, 0
  v_mov_b32 v164, 0
  v_mov_b32 v165, 0
  v_mov_b32 v166, 0
  v_mov_b32 v167, 0
  v_mov_b32 v168, 0
  v_mov_b32 v169, 0
  v_mov_b32 v170, 0
  v_mov_b32 v171, 0
  v_mov_b32 v172, 0
  v_mov_b32 v173, 0
  v_mov_b32 v174, 0
  v_mov_b32 v175, 0
  v_mov_b32 v176, 0
  v_mov_b32 v177, 0
  v_mov_b32 v178, 0
  v_mov_b32 v179, 0
  v_mov_b32 v180, 0
  v_mov_b32 v181, 0
  v_mov_b32 v182, 0
  v_mov_b32 v183, 0
  v_mov_b32 v184, 0
  v_mov_b32 v185, 0
  v_mov_b32 v186, 0
  v_mov_b32 v187, 0
  v_mov_b32 v188, 0
  v_mov_b32 v189, 0
  v_mov_b32 v190, 0
  v_mov_b32 v191, 0
  v_mov_b32 v192, 0
  v_mov_b32 v193, 0
  v_mov_b32 v194, 0
  v_mov_b32 v195, 0
  v_mov_b32 v196, 0
  v_mov_b32 v197, 0
  v_mov_b32 v198, 0
  v_mov_b32 v199, 0
  v_mov_b32 v200, 0
  v_mov_b32 v201, 0
  v_mov_b32 v202, 0
  v_mov_b32 v203, 0
  v_mov_b32 v204, 0
  v_mov_b32 v205, 0
  v_mov_b32 v206, 0
  v_mov_b32 v207, 0
  v_mov_b32 v208, 0
  v_mov_b32 v209, 0
  v_mov_b32 v210, 0
  v_mov_b32 v211, 0
  v_mov_b32 v212, 0
  v_mov_b32 v213, 0
  v_mov_b32 v214, 0
  v_mov_b32 v215, 0
  v_mov_b32 v216, 0
  v_mov_b32 v217, 0
  v_mov_b32 v218, 0
  v_mov_b32 v219, 0
  v_mov_b32 v220, 0
  v_mov_b32 v221, 0
  v_mov_b32 v222, 0
  v_mov_b32 v223, 0
  v_mov_b32 v224, 0
  v_mov_b32 v225, 0
  v_mov_b32 v226, 0
  v_mov_b32 v227, 0
  v_mov_b32 v228, 0
  v_mov_b32 v229, 0
  v_mov_b32 v230, 0
  v_mov_b32 v231, 0
  v_mov_b32 v232, 0
  v_mov_b32 v233, 0
  v_mov_b32 v234, 0
  v_mov_b32 v235, 0
  v_mov_b32 v236, 0
  v_mov_b32 v237, 0
  v_mov_b32 v238, 0
  v_mov_b32 v239, 0
  v_mov_b32 v240, 0
  v_mov_b32 v241, 0
  v_mov_b32 v242, 0
  v_mov_b32 v243, 0
  v_mov_b32 v244, 0
  v_mov_b32 v245, 0
  v_mov_b32 v246, 0
  v_mov_b32 v247, 0
  v_mov_b32 v248, 0
  v_mov_b32 v249, 0
  v_mov_b32 v250, 0
  v_mov_b32 v251, 0
  v_mov_b32 v252, 0
  v_mov_b32 v253, 0
  v_mov_b32 v254, 0
  v_mov_b32 v255, 0
  s_getpc_b64 s[64:65]
L_pc_29:
  s_sub_u32 s64, s64, L_pc_29-parallel_sum__sliding_block__glu_gated_glu__prompt_kernel
  s_subb_u32 s65, s65, 0
  s_and_b32 s65, s65, 0xffff
  s_mov_b32 s66, L_code_end-parallel_sum__sliding_block__glu_gated_glu__prompt_kernel
  s_mov_b32 s67, 0x20000
  s_lshl_b32 s48, s27, 2
  s_add_u32 s48, s48, s3
  s_lshl_b32 s48, s48, 9
  v_lshlrev_b32 v24, 7, v0
  v_add_u32 v24, s48, v24
  s_mov_b64 exec, 0xf
  buffer_load_dword v1, v24, s[64:67], 0 offen
  s_mov_b64 exec, -1
  s_mov_b32 s53, 0
  s_waitcnt lgkmcnt(0)
  s_barrier
  ds_read_b128 v[24:27], v2 offset:0
  ds_read_b64_tr_b16 v[56:57], v4 offset:0
  ds_read_b64_tr_b16 v[58:59], v4 offset:512
  ds_read_b128 v[28:31], v2 offset:2048
  ds_read_b128 v[32:35], v2 offset:4096
  ds_read_b128 v[36:39], v2 offset:6144
  ds_read_b64_tr_b16 v[60:61], v5 offset:0
  ds_read_b64_tr_b16 v[62:63], v5 offset:512
  ds_read_b64_tr_b16 v[64:65], v4 offset:16384
  ds_read_b64_tr_b16 v[66:67], v4 offset:16896
  ds_read_b64_tr_b16 v[68:69], v5 offset:16384
  ds_read_b64_tr_b16 v[70:71], v5 offset:16896
  ds_read_b64_tr_b16 v[72:73], v4 offset:32768
  ds_read_b64_tr_b16 v[74:75], v4 offset:33280
L_mloop:
  s_waitcnt lgkmcnt(11)
  v_mfma_f32_16x16x32_bf16 v[96:99], v[56:59], v[24:27], v[96:99]
  ds_read_b64_tr_b16 v[76:77], v5 offset:32768
  s_waitcnt lgkmcnt(11)
  v_mfma_f32_16x16x32_bf16 v[100:103], v[56:59], v[28:31], v[100:103]
  ds_read_b64_tr_b16 v[78:79], v5 offset:33280
  s_waitcnt lgkmcnt(11)
  v_mfma_f32_16x16x32_bf16 v[104:107], v[56:59], v[32:35], v[104:107]
  ds_read_b64_tr_b16 v[80:81], v4 offset:49152
  s_waitcnt lgkmcnt(11)
  v_mfma_f32_16x16x32_bf16 v[108:111], v[56:59], v[36:39], v[108:111]
  ds_read_b64_tr_b16 v[82:83], v4 offset:49664
  s_waitcnt lgkmcnt(10)
  v_mfma_f32_16x16x32_bf16 v[112:115], v[60:63], v[24:27], v[112:115]
  ds_read_b64_tr_b16 v[84:85], v5 offset:49152
  v_mfma_f32_16x16x32_bf16 v[116:119], v[60:63], v[28:31], v[116:119]
  ds_read_b64_tr_b16 v[86:87], v5 offset:49664
  v_mfma_f32_16x16x32_bf16 v[120:123], v[60:63], v[32:35], v[120:123]
  ds_read_b64_tr_b16 v[88:89], v6 offset:0
  v_mfma_f32_16x16x32_bf16 v[124:127], v[60:63], v[36:39], v[124:127]
  ds_read_b64_tr_b16 v[90:91], v6 offset:512
  s_waitcnt lgkmcnt(12)
  v_mfma_f32_16x16x32_bf16 v[128:131], v[64:67], v[24:27], v[128:131]
  ds_read_b64_tr_b16 v[92:93], v7 offset:0
  v_mfma_f32_16x16x32_bf16 v[132:135], v[64:67], v[28:31], v[132:135]
  ds_read_b64_tr_b16 v[94:95], v7 offset:512
  v_mfma_f32_16x16x32_bf16 v[136:139], v[64:67], v[32:35], v[136:139]
  v_mfma_f32_16x16x32_bf16 v[140:143], v[64:67], v[36:39], v[140:143]
  s_waitcnt lgkmcnt(12)
  v_mfma_f32_16x16x32_bf16 v[144:147], v[68:71], v[24:27], v[144:147]
  v_mfma_f32_16x16x32_bf16 v[148:151], v[68:71], v[28:31], v[148:151]
  v_mfma_f32_16x16x32_bf16 v[152:155], v[68:71], v[32:35], v[152:155]
  v_mfma_f32_16x16x32_bf16 v[156:159], v[68:71], v[36:39], v[156:159]
  s_waitcnt lgkmcnt(10)
  v_mfma_f32_16x16x32_bf16 v[160:163], v[72:75], v[24:27], v[160:163]
  v_mfma_f32_16x16x32_bf16 v[164:167], v[72:75], v[28:31], v[164:167]
  v_mfma_f32_16x16x32_bf16 v[168:171], v[72:75], v[32:35], v[168:171]
  v_mfma_f32_16x16x32_bf16 v[172:175], v[72:75], v[36:39], v[172:175]
  s_waitcnt lgkmcnt(0)
  s_barrier
  v_mfma_f32_16x16x32_bf16 v[176:179], v[76:79], v[24:27], v[176:179]
  ds_read_b128 v[40:43], v3 offset:0
  v_mfma_f32_16x16x32_bf16 v[180:183], v[76:79], v[28:31], v[180:183]
  ds_read_b64_tr_b16 v[56:57], v4 offset:4096
  v_mfma_f32_16x16x32_bf16 v[184:187], v[76:79], v[32:35], v[184:187]
  ds_read_b64_tr_b16 v[58:59], v4 offset:4608
  v_mfma_f32_16x16x32_bf16 v[188:191], v[76:79], v[36:39], v[188:191]
  ds_read_b128 v[44:47], v3 offset:2048
  v_mfma_f32_16x16x32_bf16 v[192:195], v[80:83], v[24:27], v[192:195]
  ds_read_b128 v[48:51], v3 offset:4096
  v_mfma_f32_16x16x32_bf16 v[196:199], v[80:83], v[28:31], v[196:199]
  ds_read_b128 v[52:55], v3 offset:6144
  v_mfma_f32_16x16x32_bf16 v[200:203], v[80:83], v[32:35], v[200:203]
  ds_read_b64_tr_b16 v[60:61], v5 offset:4096
  v_mfma_f32_16x16x32_bf16 v[204:207], v[80:83], v[36:39], v[204:207]
  ds_read_b64_tr_b16 v[62:63], v5 offset:4608
  v_mfma_f32_16x16x32_bf16 v[208:211], v[84:87], v[24:27], v[208:211]
  ds_read_b64_tr_b16 v[64:65], v4 offset:20480
  v_mfma_f32_16x16x32_bf16 v[212:215], v[84:87], v[28:31], v[212:215]
  ds_read_b64_tr_b16 v[66:67], v4 offset:20992
  v_mfma_f32_16x16x32_bf16 v[216:219], v[84:87], v[32:35], v[216:219]
  ds_read_b64_tr_b16 v[68:69], v5 offset:20480
  v_mfma_f32_16x16x32_bf16 v[220:223], v[84:87], v[36:39], v[220:223]
  ds_read_b64_tr_b16 v[70:71], v5 offset:20992
  v_mfma_f32_16x16x32_bf16 v[224:227], v[88:91], v[24:27], v[224:227]
  ds_read_b64_tr_b16 v[72:73], v4 offset:36864
  v_mfma_f32_16x16x32_bf16 v[228:231], v[88:91], v[28:31], v[228:231]
  ds_read_b64_tr_b16 v[74:75], v4 offset:37376
  v_mfma_f32_16x16x32_bf16 v[232:235], v[88:91], v[32:35], v[232:235]
  v_mfma_f32_16x16x32_bf16 v[236:239], v[88:91], v[36:39], v[236:239]
  v_mfma_f32_16x16x32_bf16 v[240:243], v[92:95], v[24:27], v[240:243]
  v_mfma_f32_16x16x32_bf16 v[244:247], v[92:95], v[28:31], v[244:247]
  v_mfma_f32_16x16x32_bf16 v[248:251], v[92:95], v[32:35], v[248:251]
  v_mfma_f32_16x16x32_bf16 v[252:255], v[92:95], v[36:39], v[252:255]
  s_waitcnt lgkmcnt(11)
  v_mfma_f32_16x16x32_bf16 v[96:99], v[56:59], v[40:43], v[96:99]
  ds_read_b64_tr_b16 v[76:77], v5 offset:36864
  s_waitcnt lgkmcnt(11)
  v_mfma_f32_16x16x32_bf16 v[100:103], v[56:59], v[44:47], v[100:103]
  ds_read_b64_tr_b16 v[78:79], v5 offset:37376
  s_waitcnt lgkmcnt(11)
  v_mfma_f32_16x16x32_bf16 v[104:107], v[56:59], v[48:51], v[104:107]
  ds_read_b64_tr_b16 v[80:81], v4 offset:53248
  s_waitcnt lgkmcnt(11)
  v_mfma_f32_16x16x32_bf16 v[108:111], v[56:59], v[52:55], v[108:111]
  ds_read_b64_tr_b16 v[82:83], v4 offset:53760
  s_waitcnt lgkmcnt(10)
  v_mfma_f32_16x16x32_bf16 v[112:115], v[60:63], v[40:43], v[112:115]
  ds_read_b64_tr_b16 v[84:85], v5 offset:53248
  v_mfma_f32_16x16x32_bf16 v[116:119], v[60:63], v[44:47], v[116:119]
  ds_read_b64_tr_b16 v[86:87], v5 offset:53760
  v_mfma_f32_16x16x32_bf16 v[120:123], v[60:63], v[48:51], v[120:123]
  ds_read_b64_tr_b16 v[88:89], v6 offset:4096
  v_mfma_f32_16x16x32_bf16 v[124:127], v[60:63], v[52:55], v[124:127]
  ds_read_b64_tr_b16 v[90:91], v6 offset:4608
  s_waitcnt lgkmcnt(12)
  v_mfma_f32_16x16x32_bf16 v[128:131], v[64:67], v[40:43], v[128:131]
  ds_read_b64_tr_b16 v[92:93], v7 offset:4096
  v_mfma_f32_16x16x32_bf16 v[132:135], v[64:67], v[44:47], v[132:135]
  ds_read_b64_tr_b16 v[94:95], v7 offset:4608
  v_mfma_f32_16x16x32_bf16 v[136:139], v[64:67], v[48:51], v[136:139]
  v_mfma_f32_16x16x32_bf16 v[140:143], v[64:67], v[52:55], v[140:143]
  s_waitcnt lgkmcnt(12)
  v_mfma_f32_16x16x32_bf16 v[144:147], v[68:71], v[40:43], v[144:147]
  v_mfma_f32_16x16x32_bf16 v[148:151], v[68:71], v[44:47], v[148:151]
  v_mfma_f32_16x16x32_bf16 v[152:155], v[68:71], v[48:51], v[152:155]
  v_mfma_f32_16x16x32_bf16 v[156:159], v[68:71], v[52:55], v[156:159]
  s_waitcnt lgkmcnt(10)
  v_mfma_f32_16x16x32_bf16 v[160:163], v[72:75], v[40:43], v[160:163]
  v_mfma_f32_16x16x32_bf16 v[164:167], v[72:75], v[44:47], v[164:167]
  v_mfma_f32_16x16x32_bf16 v[168:171], v[72:75], v[48:51], v[168:171]
  v_mfma_f32_16x16x32_bf16 v[172:175], v[72:75], v[52:55], v[172:175]
  s_waitcnt lgkmcnt(0)
  s_barrier
  v_mfma_f32_16x16x32_bf16 v[176:179], v[76:79], v[40:43], v[176:179]
  ds_read_b128 v[24:27], v2 offset:16384
  v_mfma_f32_16x16x32_bf16 v[180:183], v[76:79], v[44:47], v[180:183]
  ds_read_b64_tr_b16 v[56:57], v4 offset:8192
  v_mfma_f32_16x16x32_bf16 v[184:187], v[76:79], v[48:51], v[184:187]
  ds_read_b64_tr_b16 v[58:59], v4 offset:8704
  v_mfma_f32_16x16x32_bf16 v[188:191], v[76:79], v[52:55], v[188:191]
  ds_read_b128 v[28:31], v2 offset:18432
  v_mfma_f32_16x16x32_bf16 v[192:195], v[80:83], v[40:43], v[192:195]
  ds_read_b128 v[32:35], v2 offset:20480
  v_mfma_f32_16x16x32_bf16 v[196:199], v[80:83], v[44:47], v[196:199]
  ds_read_b128 v[36:39], v2 offset:22528
  v_mfma_f32_16x16x32_bf16 v[200:203], v[80:83], v[48:51], v[200:203]
  ds_read_b64_tr_b16 v[60:61], v5 offset:8192
  v_mfma_f32_16x16x32_bf16 v[204:207], v[80:83], v[52:55], v[204:207]
  ds_read_b64_tr_b16 v[62:63], v5 offset:8704
  v_mfma_f32_16x16x32_bf16 v[208:211], v[84:87], v[40:43], v[208:211]
  ds_read_b64_tr_b16 v[64:65], v4 offset:24576
  v_mfma_f32_16x16x32_bf16 v[212:215], v[84:87], v[44:47], v[212:215]
  ds_read_b64_tr_b16 v[66:67], v4 offset:25088
  v_mfma_f32_16x16x32_bf16 v[216:219], v[84:87], v[48:51], v[216:219]
  ds_read_b64_tr_b16 v[68:69], v5 offset:24576
  v_mfma_f32_16x16x32_bf16 v[220:223], v[84:87], v[52:55], v[220:223]
  ds_read_b64_tr_b16 v[70:71], v5 offset:25088
  v_mfma_f32_16x16x32_bf16 v[224:227], v[88:91], v[40:43], v[224:227]
  ds_read_b64_tr_b16 v[72:73], v4 offset:40960
  v_mfma_f32_16x16x32_bf16 v[228:231], v[88:91], v[44:47], v[228:231]
  ds_read_b64_tr_b16 v[74:75], v4 offset:41472
  v_mfma_f32_16x16x32_bf16 v[232:235], v[88:91], v[48:51], v[232:235]
  v_mfma_f32_16x16x32_bf16 v[236:239], v[88:91], v[52:55], v[236:239]
  v_mfma_f32_16x16x32_bf16 v[240:243], v[92:95], v[40:43], v[240:243]
  v_mfma_f32_16x16x32_bf16 v[244:247], v[92:95], v[44:47], v[244:247]
  v_mfma_f32_16x16x32_bf16 v[248:251], v[92:95], v[48:51], v[248:251]
  v_mfma_f32_16x16x32_bf16 v[252:255], v[92:95], v[52:55], v[252:255]
  s_waitcnt lgkmcnt(11)
  v_mfma_f32_16x16x32_bf16 v[96:99], v[56:59], v[24:27], v[96:99]
  ds_read_b64_tr_b16 v[76:77], v5 offset:40960
  s_waitcnt lgkmcnt(11)
  v_mfma_f32_16x16x32_bf16 v[100:103], v[56:59], v[28:31], v[100:103]
  ds_read_b64_tr_b16 v[78:79], v5 offset:41472
  s_waitcnt lgkmcnt(11)
  v_mfma_f32_16x16x32_bf16 v[104:107], v[56:59], v[32:35], v[104:107]
  ds_read_b64_tr_b16 v[80:81], v4 offset:57344
  s_waitcnt lgkmcnt(11)
  v_mfma_f32_16x16x32_bf16 v[108:111], v[56:59], v[36:39], v[108:111]
  ds_read_b64_tr_b16 v[82:83], v4 offset:57856
  s_waitcnt lgkmcnt(10)
  v_mfma_f32_16x16x32_bf16 v[112:115], v[60:63], v[24:27], v[112:115]
  ds_read_b64_tr_b16 v[84:85], v5 offset:57344
  v_mfma_f32_16x16x32_bf16 v[116:119], v[60:63], v[28:31], v[116:119]
  ds_read_b64_tr_b16 v[86:87], v5 offset:57856
  v_mfma_f32_16x16x32_bf16 v[120:123], v[60:63], v[32:35], v[120:123]
  ds_read_b64_tr_b16 v[88:89], v6 offset:8192
  v_mfma_f32_16x16x32_bf16 v[124:127], v[60:63], v[36:39], v[124:127]
  ds_read_b64_tr_b16 v[90:91], v6 offset:8704
  s_waitcnt lgkmcnt(12)
  v_mfma_f32_16x16x32_bf16 v[128:131], v[64:67], v[24:27], v[128:131]
  ds_read_b64_tr_b16 v[92:93], v7 offset:8192
  v_mfma_f32_16x16x32_bf16 v[132:135], v[64:67], v[28:31], v[132:135]
  ds_read_b64_tr_b16 v[94:95], v7 offset:8704
  v_mfma_f32_16x16x32_bf16 v[136:139], v[64:67], v[32:35], v[136:139]
  v_mfma_f32_16x16x32_bf16 v[140:143], v[64:67], v[36:39], v[140:143]
  s_waitcnt lgkmcnt(12)
  v_mfma_f32_16x16x32_bf16 v[144:147], v[68:71], v[24:27], v[144:147]
  v_mfma_f32_16x16x32_bf16 v[148:151], v[68:71], v[28:31], v[148:151]
  v_mfma_f32_16x16x32_bf16 v[152:155], v[68:71], v[32:35], v[152:155]
  v_mfma_f32_16x16x32_bf16 v[156:159], v[68:71], v[36:39], v[156:159]
  s_waitcnt lgkmcnt(10)
  v_mfma_f32_16x16x32_bf16 v[160:163], v[72:75], v[24:27], v[160:163]
  v_mfma_f32_16x16x32_bf16 v[164:167], v[72:75], v[28:31], v[164:167]
  v_mfma_f32_16x16x32_bf16 v[168:171], v[72:75], v[32:35], v[168:171]
  v_mfma_f32_16x16x32_bf16 v[172:175], v[72:75], v[36:39], v[172:175]
  s_waitcnt lgkmcnt(0)
  s_barrier
  v_mfma_f32_16x16x32_bf16 v[176:179], v[76:79], v[24:27], v[176:179]
  ds_read_b128 v[40:43], v3 offset:16384
  v_mfma_f32_16x16x32_bf16 v[180:183], v[76:79], v[28:31], v[180:183]
  ds_read_b64_tr_b16 v[56:57], v4 offset:12288
  v_mfma_f32_16x16x32_bf16 v[184:187], v[76:79], v[32:35], v[184:187]
  ds_read_b64_tr_b16 v[58:59], v4 offset:12800
  v_mfma_f32_16x16x32_bf16 v[188:191], v[76:79], v[36:39], v[188:191]
  ds_read_b128 v[44:47], v3 offset:18432
  v_mfma_f32_16x16x32_bf16 v[192:195], v[80:83], v[24:27], v[192:195]
  ds_read_b128 v[48:51], v3 offset:20480
  v_mfma_f32_16x16x32_bf16 v[196:199], v[80:83], v[28:31], v[196:199]
  ds_read_b128 v[52:55], v3 offset:22528
  v_mfma_f32_16x16x32_bf16 v[200:203], v[80:83], v[32:35], v[200:203]
  ds_read_b64_tr_b16 v[60:61], v5 offset:12288
  v_mfma_f32_16x16x32_bf16 v[204:207], v[80:83], v[36:39], v[204:207]
  ds_read_b64_tr_b16 v[62:63], v5 offset:12800
  v_mfma_f32_16x16x32_bf16 v[208:211], v[84:87], v[24:27], v[208:211]
  ds_read_b64_tr_b16 v[64:65], v4 offset:28672
  v_mfma_f32_16x16x32_bf16 v[212:215], v[84:87], v[28:31], v[212:215]
  ds_read_b64_tr_b16 v[66:67], v4 offset:29184
  v_mfma_f32_16x16x32_bf16 v[216:219], v[84:87], v[32:35], v[216:219]
  ds_read_b64_tr_b16 v[68:69], v5 offset:28672
  v_mfma_f32_16x16x32_bf16 v[220:223], v[84:87], v[36:39], v[220:223]
  ds_read_b64_tr_b16 v[70:71], v5 offset:29184
  v_mfma_f32_16x16x32_bf16 v[224:227], v[88:91], v[24:27], v[224:227]
  ds_read_b64_tr_b16 v[72:73], v4 offset:45056
  v_mfma_f32_16x16x32_bf16 v[228:231], v[88:91], v[28:31], v[228:231]
  ds_read_b64_tr_b16 v[74:75], v4 offset:45568
  v_mfma_f32_16x16x32_bf16 v[232:235], v[88:91], v[32:35], v[232:235]
  v_mfma_f32_16x16x32_bf16 v[236:239], v[88:91], v[36:39], v[236:239]
  v_mfma_f32_16x16x32_bf16 v[240:243], v[92:95], v[24:27], v[240:243]
  v_mfma_f32_16x16x32_bf16 v[244:247], v[92:95], v[28:31], v[244:247]
  v_mfma_f32_16x16x32_bf16 v[248:251], v[92:95], v[32:35], v[248:251]
  v_mfma_f32_16x16x32_bf16 v[252:255], v[92:95], v[36:39], v[252:255]
  s_waitcnt lgkmcnt(11)
  v_mfma_f32_16x16x32_bf16 v[96:99], v[56:59], v[40:43], v[96:99]
  ds_read_b64_tr_b16 v[76:77], v5 offset:45056
  s_waitcnt lgkmcnt(11)
  v_mfma_f32_16x16x32_bf16 v[100:103], v[56:59], v[44:47], v[100:103]
  ds_read_b64_tr_b16 v[78:79], v5 offset:45568
  s_waitcnt lgkmcnt(11)
  v_mfma_f32_16x16x32_bf16 v[104:107], v[56:59], v[48:51], v[104:107]
  ds_read_b64_tr_b16 v[80:81], v4 offset:61440
  s_waitcnt lgkmcnt(11)
  v_mfma_f32_16x16x32_bf16 v[108:111], v[56:59], v[52:55], v[108:111]
  ds_read_b64_tr_b16 v[82:83], v4 offset:61952
  s_waitcnt lgkmcnt(10)
  v_mfma_f32_16x16x32_bf16 v[112:115], v[60:63], v[40:43], v[112:115]
  ds_read_b64_tr_b16 v[84:85], v5 offset:61440
  v_mfma_f32_16x16x32_bf16 v[116:119], v[60:63], v[44:47], v[116:119]
  ds_read_b64_tr_b16 v[86:87], v5 offset:61952
  v_mfma_f32_16x16x32_bf16 v[120:123], v[60:63], v[48:51], v[120:123]
  ds_read_b64_tr_b16 v[88:89], v6 offset:12288
  v_mfma_f32_16x16x32_bf16 v[124:127], v[60:63], v[52:55], v[124:127]
  ds_read_b64_tr_b16 v[90:91], v6 offset:12800
  s_waitcnt lgkmcnt(12)
  v_mfma_f32_16x16x32_bf16 v[128:131], v[64:67], v[40:43], v[128:131]
  ds_read_b64_tr_b16 v[92:93], v7 offset:12288
  v_mfma_f32_16x16x32_bf16 v[132:135], v[64:67], v[44:47], v[132:135]
  ds_read_b64_tr_b16 v[94:95], v7 offset:12800
  v_mfma_f32_16x16x32_bf16 v[136:139], v[64:67], v[48:51], v[136:139]
  v_mfma_f32_16x16x32_bf16 v[140:143], v[64:67], v[52:55], v[140:143]
  s_waitcnt lgkmcnt(12)
  v_mfma_f32_16x16x32_bf16 v[144:147], v[68:71], v[40:43], v[144:147]
  v_mfma_f32_16x16x32_bf16 v[148:151], v[68:71], v[44:47], v[148:151]
  v_mfma_f32_16x16x32_bf16 v[152:155], v[68:71], v[48:51], v[152:155]
  v_mfma_f32_16x16x32_bf16 v[156:159], v[68:71], v[52:55], v[156:159]
  s_waitcnt lgkmcnt(10)
  v_mfma_f32_16x16x32_bf16 v[160:163], v[72:75], v[40:43], v[160:163]
  v_mfma_f32_16x16x32_bf16 v[164:167], v[72:75], v[44:47], v[164:167]
  v_mfma_f32_16x16x32_bf16 v[168:171], v[72:75], v[48:51], v[168:171]
  v_mfma_f32_16x16x32_bf16 v[172:175], v[72:75], v[52:55], v[172:175]
  s_waitcnt lgkmcnt(0)
  s_barrier
  v_mfma_f32_16x16x32_bf16 v[176:179], v[76:79], v[40:43], v[176:179]
  ds_read_b128 v[24:27], v2 offset:0
  v_mfma_f32_16x16x32_bf16 v[180:183], v[76:79], v[44:47], v[180:183]
  ds_read_b64_tr_b16 v[56:57], v4 offset:0
  v_mfma_f32_16x16x32_bf16 v[184:187], v[76:79], v[48:51], v[184:187]
  ds_read_b64_tr_b16 v[58:59], v4 offset:512
  v_mfma_f32_16x16x32_bf16 v[188:191], v[76:79], v[52:55], v[188:191]
  ds_read_b128 v[28:31], v2 offset:2048
  v_mfma_f32_16x16x32_bf16 v[192:195], v[80:83], v[40:43], v[192:195]
  ds_read_b128 v[32:35], v2 offset:4096
  v_mfma_f32_16x16x32_bf16 v[196:199], v[80:83], v[44:47], v[196:199]
  ds_read_b128 v[36:39], v2 offset:6144
  v_mfma_f32_16x16x32_bf16 v[200:203], v[80:83], v[48:51], v[200:203]
  ds_read_b64_tr_b16 v[60:61], v5 offset:0
  v_mfma_f32_16x16x32_bf16 v[204:207], v[80:83], v[52:55], v[204:207]
  ds_read_b64_tr_b16 v[62:63], v5 offset:512
  v_mfma_f32_16x16x32_bf16 v[208:211], v[84:87], v[40:43], v[208:211]
  ds_read_b64_tr_b16 v[64:65], v4 offset:16384
  v_mfma_f32_16x16x32_bf16 v[212:215], v[84:87], v[44:47], v[212:215]
  ds_read_b64_tr_b16 v[66:67], v4 offset:16896
  v_mfma_f32_16x16x32_bf16 v[216:219], v[84:87], v[48:51], v[216:219]
  ds_read_b64_tr_b16 v[68:69], v5 offset:16384
  v_mfma_f32_16x16x32_bf16 v[220:223], v[84:87], v[52:55], v[220:223]
  ds_read_b64_tr_b16 v[70:71], v5 offset:16896
  v_mfma_f32_16x16x32_bf16 v[224:227], v[88:91], v[40:43], v[224:227]
  ds_read_b64_tr_b16 v[72:73], v4 offset:32768
  v_mfma_f32_16x16x32_bf16 v[228:231], v[88:91], v[44:47], v[228:231]
  ds_read_b64_tr_b16 v[74:75], v4 offset:33280
  v_mfma_f32_16x16x32_bf16 v[232:235], v[88:91], v[48:51], v[232:235]
  v_mfma_f32_16x16x32_bf16 v[236:239], v[88:91], v[52:55], v[236:239]
  v_mfma_f32_16x16x32_bf16 v[240:243], v[92:95], v[40:43], v[240:243]
  v_mfma_f32_16x16x32_bf16 v[244:247], v[92:95], v[44:47], v[244:247]
  v_mfma_f32_16x16x32_bf16 v[248:251], v[92:95], v[48:51], v[248:251]
  v_mfma_f32_16x16x32_bf16 v[252:255], v[92:95], v[52:55], v[252:255]
  s_add_u32 s53, s53, 1
  s_cmp_eq_u32 s53, 1
  s_cbranch_scc1 L_m_pub
L_m_back:
  s_cmp_lt_u32 s53, 4
  s_cbranch_scc1 L_mloop
  s_branch L_m_last
L_m_pub:
  s_cmp_lg_u32 s3, 0
  s_cbranch_scc1 L_m_back
  s_waitcnt vmcnt(0)
  v_cmp_eq_u32 vcc, 0, v20
  s_nop 1
  v_cndmask_b32 v20, v20, v23, vcc
  v_mov_b32 v22, 155136
  s_mov_b64 exec, 1
  ds_write_b32 v22, v20
  s_mov_b64 exec, -1
  s_waitcnt lgkmcnt(0)
  s_branch L_m_back
L_m_last:
  s_waitcnt lgkmcnt(11)
  v_mfma_f32_16x16x32_bf16 v[96:99], v[56:59], v[24:27], v[96:99]
  ds_read_b64_tr_b16 v[76:77], v5 offset:32768
  s_waitcnt lgkmcnt(11)
  v_mfma_f32_16x16x32_bf16 v[100:103], v[56:59], v[28:31], v[100:103]
  ds_read_b64_tr_b16 v[78:79], v5 offset:33280
  s_waitcnt lgkmcnt(11)
  v_mfma_f32_16x16x32_bf16 v[104:107], v[56:59], v[32:35], v[104:107]
  ds_read_b64_tr_b16 v[80:81], v4 offset:49152
  s_waitcnt lgkmcnt(11)
  v_mfma_f32_16x16x32_bf16 v[108:111], v[56:59], v[36:39], v[108:111]
  ds_read_b64_tr_b16 v[82:83], v4 offset:49664
  s_waitcnt lgkmcnt(10)
  v_mfma_f32_16x16x32_bf16 v[112:115], v[60:63], v[24:27], v[112:115]
  ds_read_b64_tr_b16 v[84:85], v5 offset:49152
  v_mfma_f32_16x16x32_bf16 v[116:119], v[60:63], v[28:31], v[116:119]
  ds_read_b64_tr_b16 v[86:87], v5 offset:49664
  v_mfma_f32_16x16x32_bf16 v[120:123], v[60:63], v[32:35], v[120:123]
  ds_read_b64_tr_b16 v[88:89], v6 offset:0
  v_mfma_f32_16x16x32_bf16 v[124:127], v[60:63], v[36:39], v[124:127]
  ds_read_b64_tr_b16 v[90:91], v6 offset:512
  s_waitcnt lgkmcnt(12)
  v_mfma_f32_16x16x32_bf16 v[128:131], v[64:67], v[24:27], v[128:131]
  ds_read_b64_tr_b16 v[92:93], v7 offset:0
  v_mfma_f32_16x16x32_bf16 v[132:135], v[64:67], v[28:31], v[132:135]
  ds_read_b64_tr_b16 v[94:95], v7 offset:512
  v_mfma_f32_16x16x32_bf16 v[136:139], v[64:67], v[32:35], v[136:139]
  v_mfma_f32_16x16x32_bf16 v[140:143], v[64:67], v[36:39], v[140:143]
  s_waitcnt lgkmcnt(12)
  v_mfma_f32_16x16x32_bf16 v[144:147], v[68:71], v[24:27], v[144:147]
  v_mfma_f32_16x16x32_bf16 v[148:151], v[68:71], v[28:31], v[148:151]
  v_mfma_f32_16x16x32_bf16 v[152:155], v[68:71], v[32:35], v[152:155]
  v_mfma_f32_16x16x32_bf16 v[156:159], v[68:71], v[36:39], v[156:159]
  s_waitcnt lgkmcnt(10)
  v_mfma_f32_16x16x32_bf16 v[160:163], v[72:75], v[24:27], v[160:163]
  v_mfma_f32_16x16x32_bf16 v[164:167], v[72:75], v[28:31], v[164:167]
  v_mfma_f32_16x16x32_bf16 v[168:171], v[72:75], v[32:35], v[168:171]
  v_mfma_f32_16x16x32_bf16 v[172:175], v[72:75], v[36:39], v[172:175]
  s_waitcnt lgkmcnt(0)
  s_barrier
  v_mfma_f32_16x16x32_bf16 v[176:179], v[76:79], v[24:27], v[176:179]
  ds_read_b128 v[40:43], v3 offset:0
  v_mfma_f32_16x16x32_bf16 v[180:183], v[76:79], v[28:31], v[180:183]
  ds_read_b64_tr_b16 v[56:57], v4 offset:4096
  v_mfma_f32_16x16x32_bf16 v[184:187], v[76:79], v[32:35], v[184:187]
  ds_read_b64_tr_b16 v[58:59], v4 offset:4608
  v_mfma_f32_16x16x32_bf16 v[188:191], v[76:79], v[36:39], v[188:191]
  ds_read_b128 v[44:47], v3 offset:2048
  v_mfma_f32_16x16x32_bf16 v[192:195], v[80:83], v[24:27], v[192:195]
  ds_read_b128 v[48:51], v3 offset:4096
  v_mfma_f32_16x16x32_bf16 v[196:199], v[80:83], v[28:31], v[196:199]
  ds_read_b128 v[52:55], v3 offset:6144
  v_mfma_f32_16x16x32_bf16 v[200:203], v[80:83], v[32:35], v[200:203]
  ds_read_b64_tr_b16 v[60:61], v5 offset:4096
  v_mfma_f32_16x16x32_bf16 v[204:207], v[80:83], v[36:39], v[204:207]
  ds_read_b64_tr_b16 v[62:63], v5 offset:4608
  v_mfma_f32_16x16x32_bf16 v[208:211], v[84:87], v[24:27], v[208:211]
  ds_read_b64_tr_b16 v[64:65], v4 offset:20480
  v_mfma_f32_16x16x32_bf16 v[212:215], v[84:87], v[28:31], v[212:215]
  ds_read_b64_tr_b16 v[66:67], v4 offset:20992
  v_mfma_f32_16x16x32_bf16 v[216:219], v[84:87], v[32:35], v[216:219]
  ds_read_b64_tr_b16 v[68:69], v5 offset:20480
  v_mfma_f32_16x16x32_bf16 v[220:223], v[84:87], v[36:39], v[220:223]
  ds_read_b64_tr_b16 v[70:71], v5 offset:20992
  v_mfma_f32_16x16x32_bf16 v[224:227], v[88:91], v[24:27], v[224:227]
  ds_read_b64_tr_b16 v[72:73], v4 offset:36864
  v_mfma_f32_16x16x32_bf16 v[228:231], v[88:91], v[28:31], v[228:231]
  ds_read_b64_tr_b16 v[74:75], v4 offset:37376
  v_mfma_f32_16x16x32_bf16 v[232:235], v[88:91], v[32:35], v[232:235]
  v_mfma_f32_16x16x32_bf16 v[236:239], v[88:91], v[36:39], v[236:239]
  v_mfma_f32_16x16x32_bf16 v[240:243], v[92:95], v[24:27], v[240:243]
  v_mfma_f32_16x16x32_bf16 v[244:247], v[92:95], v[28:31], v[244:247]
  v_mfma_f32_16x16x32_bf16 v[248:251], v[92:95], v[32:35], v[248:251]
  v_mfma_f32_16x16x32_bf16 v[252:255], v[92:95], v[36:39], v[252:255]
  s_waitcnt lgkmcnt(11)
  v_mfma_f32_16x16x32_bf16 v[96:99], v[56:59], v[40:43], v[96:99]
  ds_read_b64_tr_b16 v[76:77], v5 offset:36864
  s_waitcnt lgkmcnt(11)
  v_mfma_f32_16x16x32_bf16 v[100:103], v[56:59], v[44:47], v[100:103]
  ds_read_b64_tr_b16 v[78:79], v5 offset:37376
  s_waitcnt lgkmcnt(11)
  v_mfma_f32_16x16x32_bf16 v[104:107], v[56:59], v[48:51], v[104:107]
  ds_read_b64_tr_b16 v[80:81], v4 offset:53248
  s_waitcnt lgkmcnt(11)
  v_mfma_f32_16x16x32_bf16 v[108:111], v[56:59], v[52:55], v[108:111]
  ds_read_b64_tr_b16 v[82:83], v4 offset:53760
  s_waitcnt lgkmcnt(10)
  v_mfma_f32_16x16x32_bf16 v[112:115], v[60:63], v[40:43], v[112:115]
  ds_read_b64_tr_b16 v[84:85], v5 offset:53248
  v_mfma_f32_16x16x32_bf16 v[116:119], v[60:63], v[44:47], v[116:119]
  ds_read_b64_tr_b16 v[86:87], v5 offset:53760
  v_mfma_f32_16x16x32_bf16 v[120:123], v[60:63], v[48:51], v[120:123]
  ds_read_b64_tr_b16 v[88:89], v6 offset:4096
  v_mfma_f32_16x16x32_bf16 v[124:127], v[60:63], v[52:55], v[124:127]
  ds_read_b64_tr_b16 v[90:91], v6 offset:4608
  s_waitcnt lgkmcnt(12)
  v_mfma_f32_16x16x32_bf16 v[128:131], v[64:67], v[40:43], v[128:131]
  ds_read_b64_tr_b16 v[92:93], v7 offset:4096
  v_mfma_f32_16x16x32_bf16 v[132:135], v[64:67], v[44:47], v[132:135]
  ds_read_b64_tr_b16 v[94:95], v7 offset:4608
  v_mfma_f32_16x16x32_bf16 v[136:139], v[64:67], v[48:51], v[136:139]
  v_mfma_f32_16x16x32_bf16 v[140:143], v[64:67], v[52:55], v[140:143]
  s_waitcnt lgkmcnt(12)
  v_mfma_f32_16x16x32_bf16 v[144:147], v[68:71], v[40:43], v[144:147]
  v_mfma_f32_16x16x32_bf16 v[148:151], v[68:71], v[44:47], v[148:151]
  v_mfma_f32_16x16x32_bf16 v[152:155], v[68:71], v[48:51], v[152:155]
  v_mfma_f32_16x16x32_bf16 v[156:159], v[68:71], v[52:55], v[156:159]
  s_waitcnt lgkmcnt(10)
  v_mfma_f32_16x16x32_bf16 v[160:163], v[72:75], v[40:43], v[160:163]
  v_mfma_f32_16x16x32_bf16 v[164:167], v[72:75], v[44:47], v[164:167]
  v_mfma_f32_16x16x32_bf16 v[168:171], v[72:75], v[48:51], v[168:171]
  v_mfma_f32_16x16x32_bf16 v[172:175], v[72:75], v[52:55], v[172:175]
  s_waitcnt lgkmcnt(0)
  s_barrier
  v_mfma_f32_16x16x32_bf16 v[176:179], v[76:79], v[40:43], v[176:179]
  ds_read_b128 v[24:27], v2 offset:16384
  v_mfma_f32_16x16x32_bf16 v[180:183], v[76:79], v[44:47], v[180:183]
  ds_read_b64_tr_b16 v[56:57], v4 offset:8192
  v_mfma_f32_16x16x32_bf16 v[184:187], v[76:79], v[48:51], v[184:187]
  ds_read_b64_tr_b16 v[58:59], v4 offset:8704
  v_mfma_f32_16x16x32_bf16 v[188:191], v[76:79], v[52:55], v[188:191]
  ds_read_b128 v[28:31], v2 offset:18432
  v_mfma_f32_16x16x32_bf16 v[192:195], v[80:83], v[40:43], v[192:195]
  ds_read_b128 v[32:35], v2 offset:20480
  v_mfma_f32_16x16x32_bf16 v[196:199], v[80:83], v[44:47], v[196:199]
  ds_read_b128 v[36:39], v2 offset:22528
  v_mfma_f32_16x16x32_bf16 v[200:203], v[80:83], v[48:51], v[200:203]
  ds_read_b64_tr_b16 v[60:61], v5 offset:8192
  v_mfma_f32_16x16x32_bf16 v[204:207], v[80:83], v[52:55], v[204:207]
  ds_read_b64_tr_b16 v[62:63], v5 offset:8704
  v_mfma_f32_16x16x32_bf16 v[208:211], v[84:87], v[40:43], v[208:211]
  ds_read_b64_tr_b16 v[64:65], v4 offset:24576
  v_mfma_f32_16x16x32_bf16 v[212:215], v[84:87], v[44:47], v[212:215]
  ds_read_b64_tr_b16 v[66:67], v4 offset:25088
  v_mfma_f32_16x16x32_bf16 v[216:219], v[84:87], v[48:51], v[216:219]
  ds_read_b64_tr_b16 v[68:69], v5 offset:24576
  v_mfma_f32_16x16x32_bf16 v[220:223], v[84:87], v[52:55], v[220:223]
  ds_read_b64_tr_b16 v[70:71], v5 offset:25088
  v_mfma_f32_16x16x32_bf16 v[224:227], v[88:91], v[40:43], v[224:227]
  ds_read_b64_tr_b16 v[72:73], v4 offset:40960
  v_mfma_f32_16x16x32_bf16 v[228:231], v[88:91], v[44:47], v[228:231]
  ds_read_b64_tr_b16 v[74:75], v4 offset:41472
  v_mfma_f32_16x16x32_bf16 v[232:235], v[88:91], v[48:51], v[232:235]
  v_mfma_f32_16x16x32_bf16 v[236:239], v[88:91], v[52:55], v[236:239]
  v_mfma_f32_16x16x32_bf16 v[240:243], v[92:95], v[40:43], v[240:243]
  v_mfma_f32_16x16x32_bf16 v[244:247], v[92:95], v[44:47], v[244:247]
  v_mfma_f32_16x16x32_bf16 v[248:251], v[92:95], v[48:51], v[248:251]
  v_mfma_f32_16x16x32_bf16 v[252:255], v[92:95], v[52:55], v[252:255]
  s_waitcnt lgkmcnt(11)
  v_mfma_f32_16x16x32_bf16 v[96:99], v[56:59], v[24:27], v[96:99]
  ds_read_b64_tr_b16 v[76:77], v5 offset:40960
  s_waitcnt lgkmcnt(11)
  v_mfma_f32_16x16x32_bf16 v[100:103], v[56:59], v[28:31], v[100:103]
  ds_read_b64_tr_b16 v[78:79], v5 offset:41472
  s_waitcnt lgkmcnt(11)
  v_mfma_f32_16x16x32_bf16 v[104:107], v[56:59], v[32:35], v[104:107]
  ds_read_b64_tr_b16 v[80:81], v4 offset:57344
  s_waitcnt lgkmcnt(11)
  v_mfma_f32_16x16x32_bf16 v[108:111], v[56:59], v[36:39], v[108:111]
  ds_read_b64_tr_b16 v[82:83], v4 offset:57856
  s_waitcnt lgkmcnt(10)
  v_mfma_f32_16x16x32_bf16 v[112:115], v[60:63], v[24:27], v[112:115]
  ds_read_b64_tr_b16 v[84:85], v5 offset:57344
  v_mfma_f32_16x16x32_bf16 v[116:119], v[60:63], v[28:31], v[116:119]
  ds_read_b64_tr_b16 v[86:87], v5 offset:57856
  v_mfma_f32_16x16x32_bf16 v[120:123], v[60:63], v[32:35], v[120:123]
  ds_read_b64_tr_b16 v[88:89], v6 offset:8192
  v_mfma_f32_16x16x32_bf16 v[124:127], v[60:63], v[36:39], v[124:127]
  ds_read_b64_tr_b16 v[90:91], v6 offset:8704
  s_waitcnt lgkmcnt(12)
  v_mfma_f32_16x16x32_bf16 v[128:131], v[64:67], v[24:27], v[128:131]
  ds_read_b64_tr_b16 v[92:93], v7 offset:8192
  v_mfma_f32_16x16x32_bf16 v[132:135], v[64:67], v[28:31], v[132:135]
  ds_read_b64_tr_b16 v[94:95], v7 offset:8704
  v_mfma_f32_16x16x32_bf16 v[136:139], v[64:67], v[32:35], v[136:139]
  v_mfma_f32_16x16x32_bf16 v[140:143], v[64:67], v[36:39], v[140:143]
  s_waitcnt lgkmcnt(12)
  v_mfma_f32_16x16x32_bf16 v[144:147], v[68:71], v[24:27], v[144:147]
  v_mfma_f32_16x16x32_bf16 v[148:151], v[68:71], v[28:31], v[148:151]
  v_mfma_f32_16x16x32_bf16 v[152:155], v[68:71], v[32:35], v[152:155]
  v_mfma_f32_16x16x32_bf16 v[156:159], v[68:71], v[36:39], v[156:159]
  s_waitcnt lgkmcnt(10)
  v_mfma_f32_16x16x32_bf16 v[160:163], v[72:75], v[24:27], v[160:163]
  v_mfma_f32_16x16x32_bf16 v[164:167], v[72:75], v[28:31], v[164:167]
  v_mfma_f32_16x16x32_bf16 v[168:171], v[72:75], v[32:35], v[168:171]
  v_mfma_f32_16x16x32_bf16 v[172:175], v[72:75], v[36:39], v[172:175]
  s_waitcnt lgkmcnt(0)
  s_barrier
  v_mfma_f32_16x16x32_bf16 v[176:179], v[76:79], v[24:27], v[176:179]
  ds_read_b128 v[40:43], v3 offset:16384
  v_mfma_f32_16x16x32_bf16 v[180:183], v[76:79], v[28:31], v[180:183]
  ds_read_b64_tr_b16 v[56:57], v4 offset:12288
  v_mfma_f32_16x16x32_bf16 v[184:187], v[76:79], v[32:35], v[184:187]
  ds_read_b64_tr_b16 v[58:59], v4 offset:12800
  v_mfma_f32_16x16x32_bf16 v[188:191], v[76:79], v[36:39], v[188:191]
  ds_read_b128 v[44:47], v3 offset:18432
  v_mfma_f32_16x16x32_bf16 v[192:195], v[80:83], v[24:27], v[192:195]
  ds_read_b128 v[48:51], v3 offset:20480
  v_mfma_f32_16x16x32_bf16 v[196:199], v[80:83], v[28:31], v[196:199]
  ds_read_b128 v[52:55], v3 offset:22528
  v_mfma_f32_16x16x32_bf16 v[200:203], v[80:83], v[32:35], v[200:203]
  ds_read_b64_tr_b16 v[60:61], v5 offset:12288
  v_mfma_f32_16x16x32_bf16 v[204:207], v[80:83], v[36:39], v[204:207]
  ds_read_b64_tr_b16 v[62:63], v5 offset:12800
  v_mfma_f32_16x16x32_bf16 v[208:211], v[84:87], v[24:27], v[208:211]
  ds_read_b64_tr_b16 v[64:65], v4 offset:28672
  v_mfma_f32_16x16x32_bf16 v[212:215], v[84:87], v[28:31], v[212:215]
  ds_read_b64_tr_b16 v[66:67], v4 offset:29184
  v_mfma_f32_16x16x32_bf16 v[216:219], v[84:87], v[32:35], v[216:219]
  ds_read_b64_tr_b16 v[68:69], v5 offset:28672
  v_mfma_f32_16x16x32_bf16 v[220:223], v[84:87], v[36:39], v[220:223]
  ds_read_b64_tr_b16 v[70:71], v5 offset:29184
  v_mfma_f32_16x16x32_bf16 v[224:227], v[88:91], v[24:27], v[224:227]
  ds_read_b64_tr_b16 v[72:73], v4 offset:45056
  v_mfma_f32_16x16x32_bf16 v[228:231], v[88:91], v[28:31], v[228:231]
  ds_read_b64_tr_b16 v[74:75], v4 offset:45568
  v_mfma_f32_16x16x32_bf16 v[232:235], v[88:91], v[32:35], v[232:235]
  v_mfma_f32_16x16x32_bf16 v[236:239], v[88:91], v[36:39], v[236:239]
  v_mfma_f32_16x16x32_bf16 v[240:243], v[92:95], v[24:27], v[240:243]
  v_mfma_f32_16x16x32_bf16 v[244:247], v[92:95], v[28:31], v[244:247]
  v_mfma_f32_16x16x32_bf16 v[248:251], v[92:95], v[32:35], v[248:251]
  v_mfma_f32_16x16x32_bf16 v[252:255], v[92:95], v[36:39], v[252:255]
  s_waitcnt lgkmcnt(11)
  v_mfma_f32_16x16x32_bf16 v[96:99], v[56:59], v[40:43], v[96:99]
  ds_read_b64_tr_b16 v[76:77], v5 offset:45056
  s_waitcnt lgkmcnt(11)
  v_mfma_f32_16x16x32_bf16 v[100:103], v[56:59], v[44:47], v[100:103]
  ds_read_b64_tr_b16 v[78:79], v5 offset:45568
  s_waitcnt lgkmcnt(11)
  v_mfma_f32_16x16x32_bf16 v[104:107], v[56:59], v[48:51], v[104:107]
  ds_read_b64_tr_b16 v[80:81], v4 offset:61440
  s_waitcnt lgkmcnt(11)
  v_mfma_f32_16x16x32_bf16 v[108:111], v[56:59], v[52:55], v[108:111]
  ds_read_b64_tr_b16 v[82:83], v4 offset:61952
  s_waitcnt lgkmcnt(10)
  v_mfma_f32_16x16x32_bf16 v[112:115], v[60:63], v[40:43], v[112:115]
  ds_read_b64_tr_b16 v[84:85], v5 offset:61440
  v_mfma_f32_16x16x32_bf16 v[116:119], v[60:63], v[44:47], v[116:119]
  ds_read_b64_tr_b16 v[86:87], v5 offset:61952
  v_mfma_f32_16x16x32_bf16 v[120:123], v[60:63], v[48:51], v[120:123]
  ds_read_b64_tr_b16 v[88:89], v6 offset:12288
  v_mfma_f32_16x16x32_bf16 v[124:127], v[60:63], v[52:55], v[124:127]
  ds_read_b64_tr_b16 v[90:91], v6 offset:12800
  s_waitcnt lgkmcnt(12)
  v_mfma_f32_16x16x32_bf16 v[128:131], v[64:67], v[40:43], v[128:131]
  ds_read_b64_tr_b16 v[92:93], v7 offset:12288
  v_mfma_f32_16x16x32_bf16 v[132:135], v[64:67], v[44:47], v[132:135]
  ds_read_b64_tr_b16 v[94:95], v7 offset:12800
  v_mfma_f32_16x16x32_bf16 v[136:139], v[64:67], v[48:51], v[136:139]
  v_mfma_f32_16x16x32_bf16 v[140:143], v[64:67], v[52:55], v[140:143]
  s_waitcnt lgkmcnt(12)
  v_mfma_f32_16x16x32_bf16 v[144:147], v[68:71], v[40:43], v[144:147]
  v_mfma_f32_16x16x32_bf16 v[148:151], v[68:71], v[44:47], v[148:151]
  v_mfma_f32_16x16x32_bf16 v[152:155], v[68:71], v[48:51], v[152:155]
  v_mfma_f32_16x16x32_bf16 v[156:159], v[68:71], v[52:55], v[156:159]
  s_waitcnt lgkmcnt(10)
  v_mfma_f32_16x16x32_bf16 v[160:163], v[72:75], v[40:43], v[160:163]
  v_mfma_f32_16x16x32_bf16 v[164:167], v[72:75], v[44:47], v[164:167]
  v_mfma_f32_16x16x32_bf16 v[168:171], v[72:75], v[48:51], v[168:171]
  v_mfma_f32_16x16x32_bf16 v[172:175], v[72:75], v[52:55], v[172:175]
  s_waitcnt lgkmcnt(0)
  s_barrier
  v_mfma_f32_16x16x32_bf16 v[176:179], v[76:79], v[40:43], v[176:179]
  ds_read_b128 v[24:27], v10 offset:0
  v_mfma_f32_16x16x32_bf16 v[180:183], v[76:79], v[44:47], v[180:183]
  ds_read_b128 v[28:31], v10 offset:256
  v_mfma_f32_16x16x32_bf16 v[184:187], v[76:79], v[48:51], v[184:187]
  ds_read_b128 v[32:35], v10 offset:512
  v_mfma_f32_16x16x32_bf16 v[188:191], v[76:79], v[52:55], v[188:191]
  ds_read_b128 v[36:39], v10 offset:768
  v_mfma_f32_16x16x32_bf16 v[192:195], v[80:83], v[40:43], v[192:195]
  ds_read_b128 v[56:59], v11 offset:0
  v_mfma_f32_16x16x32_bf16 v[196:199], v[80:83], v[44:47], v[196:199]
  ds_read_b128 v[60:63], v11 offset:64
  v_mfma_f32_16x16x32_bf16 v[200:203], v[80:83], v[48:51], v[200:203]
  ds_read_b128 v[64:67], v11 offset:256
  v_mfma_f32_16x16x32_bf16 v[204:207], v[80:83], v[52:55], v[204:207]
  ds_read_b128 v[68:71], v11 offset:320
  v_mfma_f32_16x16x32_bf16 v[208:211], v[84:87], v[40:43], v[208:211]
  ds_read_b128 v[72:75], v11 offset:512
  v_mfma_f32_16x16x32_bf16 v[212:215], v[84:87], v[44:47], v[212:215]
  v_mfma_f32_16x16x32_bf16 v[216:219], v[84:87], v[48:51], v[216:219]
  v_mfma_f32_16x16x32_bf16 v[220:223], v[84:87], v[52:55], v[220:223]
  v_mfma_f32_16x16x32_bf16 v[224:227], v[88:91], v[40:43], v[224:227]
  v_mfma_f32_16x16x32_bf16 v[228:231], v[88:91], v[44:47], v[228:231]
  v_mfma_f32_16x16x32_bf16 v[232:235], v[88:91], v[48:51], v[232:235]
  v_mfma_f32_16x16x32_bf16 v[236:239], v[88:91], v[52:55], v[236:239]
  v_mfma_f32_16x16x32_bf16 v[240:243], v[92:95], v[40:43], v[240:243]
  v_mfma_f32_16x16x32_bf16 v[244:247], v[92:95], v[44:47], v[244:247]
  v_mfma_f32_16x16x32_bf16 v[248:251], v[92:95], v[48:51], v[248:251]
  v_mfma_f32_16x16x32_bf16 v[252:255], v[92:95], v[52:55], v[252:255]
  ds_read_b128 v[76:79], v11 offset:576
  ds_read_b128 v[80:83], v11 offset:768
  ds_read_b128 v[84:87], v11 offset:832
  ds_read_b128 v[88:91], v11 offset:1024
  ds_read_b128 v[92:95], v11 offset:1088
  v_mov_b32 v22, 155136
  ds_read_b32 v23, v22
  v_and_b32 v16, 15, v0
  v_lshlrev_b32 v16, 4, v16
  v_bfe_u32 v17, v0, 4, 1
  v_lshl_add_u32 v16, v17, 11, v16
  v_lshrrev_b32 v17, 5, v0
  v_lshl_add_u32 v16, v17, 10, v16
  v_mov_b32 v17, 0
  s_lshl_b32 s59, s24, 1
  s_add_u32 s59, s59, s50
  s_mul_i32 s60, s59, 245760
  s_mul_i32 s61, s59, 196608
  s_add_u32 s61, s61, 7864320
  s_lshl_b32 s67, s24, 5
  s_add_u32 s67, s67, s25
  s_lshl_b32 s67, s67, 2
  v_mov_b32 v19, 155144
  v_mov_b32 v21, 155148
  s_add_u32 s68, s67, 19681280
  s_add_u32 s67, s67, 19677184
  s_lshl_b32 s49, s56, 12
  s_add_u32 s60, s60, s49
  s_add_u32 s61, s61, s49
  s_cmp_ge_u32 s25, 8
  s_cbranch_scc1 L_epi_b
  s_lshl_b32 s62, s25, 13
  s_add_u32 s62, s62, s60
  s_mov_b32 s48, 1051011932
  s_cmp_lt_u32 s25, 10
  s_cselect_b32 s48, s48, 1.0
  s_waitcnt lgkmcnt(14)
  v_mul_f32 v27, s48, v25
  s_waitcnt lgkmcnt(13)
  v_mul_f32 v31, s48, v29
  s_waitcnt lgkmcnt(12)
  v_mul_f32 v35, s48, v33
  s_waitcnt lgkmcnt(11)
  v_mul_f32 v39, s48, v37
  s_nop 4
  s_waitcnt lgkmcnt(2)
  v_pk_fma_f32 v[224:225], v[88:89], v[24:25], v[224:225] op_sel_hi:[1,0,1]
  v_pk_fma_f32 v[226:227], v[90:91], v[24:25], v[226:227] op_sel_hi:[1,0,1]
  v_pk_fma_f32 v[228:229], v[88:89], v[28:29], v[228:229] op_sel_hi:[1,0,1]
  v_pk_fma_f32 v[230:231], v[90:91], v[28:29], v[230:231] op_sel_hi:[1,0,1]
  v_pk_fma_f32 v[232:233], v[88:89], v[32:33], v[232:233] op_sel_hi:[1,0,1]
  v_pk_fma_f32 v[234:235], v[90:91], v[32:33], v[234:235] op_sel_hi:[1,0,1]
  v_pk_fma_f32 v[236:237], v[88:89], v[36:37], v[236:237] op_sel_hi:[1,0,1]
  v_pk_fma_f32 v[238:239], v[90:91], v[36:37], v[238:239] op_sel_hi:[1,0,1]
  s_waitcnt lgkmcnt(1)
  v_pk_fma_f32 v[240:241], v[92:93], v[24:25], v[240:241] op_sel_hi:[1,0,1]
  v_pk_fma_f32 v[242:243], v[94:95], v[24:25], v[242:243] op_sel_hi:[1,0,1]
  v_pk_fma_f32 v[244:245], v[92:93], v[28:29], v[244:245] op_sel_hi:[1,0,1]
  v_pk_fma_f32 v[246:247], v[94:95], v[28:29], v[246:247] op_sel_hi:[1,0,1]
  v_pk_fma_f32 v[248:249], v[92:93], v[32:33], v[248:249] op_sel_hi:[1,0,1]
  v_pk_fma_f32 v[250:251], v[94:95], v[32:33], v[250:251] op_sel_hi:[1,0,1]
  v_pk_fma_f32 v[252:253], v[92:93], v[36:37], v[252:253] op_sel_hi:[1,0,1]
  v_pk_fma_f32 v[254:255], v[94:95], v[36:37], v[254:255] op_sel_hi:[1,0,1]
  v_pk_mul_f32 v[224:225], v[224:225], v[26:27] op_sel:[0,1] op_sel_hi:[1,1]
  v_pk_mul_f32 v[226:227], v[226:227], v[26:27] op_sel:[0,1] op_sel_hi:[1,1]
  v_pk_mul_f32 v[240:241], v[240:241], v[26:27] op_sel:[0,1] op_sel_hi:[1,1]
  v_pk_mul_f32 v[242:243], v[242:243], v[26:27] op_sel:[0,1] op_sel_hi:[1,1]
  v_pk_mul_f32 v[228:229], v[228:229], v[30:31] op_sel:[0,1] op_sel_hi:[1,1]
  v_pk_mul_f32 v[230:231], v[230:231], v[30:31] op_sel:[0,1] op_sel_hi:[1,1]
  v_pk_mul_f32 v[244:245], v[244:245], v[30:31] op_sel:[0,1] op_sel_hi:[1,1]
  v_pk_mul_f32 v[246:247], v[246:247], v[30:31] op_sel:[0,1] op_sel_hi:[1,1]
  v_pk_mul_f32 v[232:233], v[232:233], v[34:35] op_sel:[0,1] op_sel_hi:[1,1]
  v_pk_mul_f32 v[234:235], v[234:235], v[34:35] op_sel:[0,1] op_sel_hi:[1,1]
  v_pk_mul_f32 v[248:249], v[248:249], v[34:35] op_sel:[0,1] op_sel_hi:[1,1]
  v_pk_mul_f32 v[250:251], v[250:251], v[34:35] op_sel:[0,1] op_sel_hi:[1,1]
  v_pk_mul_f32 v[236:237], v[236:237], v[38:39] op_sel:[0,1] op_sel_hi:[1,1]
  v_pk_mul_f32 v[238:239], v[238:239], v[38:39] op_sel:[0,1] op_sel_hi:[1,1]
  v_pk_mul_f32 v[252:253], v[252:253], v[38:39] op_sel:[0,1] op_sel_hi:[1,1]
  v_pk_mul_f32 v[254:255], v[254:255], v[38:39] op_sel:[0,1] op_sel_hi:[1,1]
  v_cvt_pk_bf16_f32 v224, v224, v225
  v_cvt_pk_bf16_f32 v225, v226, v227
  v_cvt_pk_bf16_f32 v226, v240, v241
  v_cvt_pk_bf16_f32 v227, v242, v243
  v_cvt_pk_bf16_f32 v228, v228, v229
  v_cvt_pk_bf16_f32 v229, v230, v231
  v_cvt_pk_bf16_f32 v230, v244, v245
  v_cvt_pk_bf16_f32 v231, v246, v247
  v_cvt_pk_bf16_f32 v232, v232, v233
  v_cvt_pk_bf16_f32 v233, v234, v235
  v_cvt_pk_bf16_f32 v234, v248, v249
  v_cvt_pk_bf16_f32 v235, v250, v251
  v_cvt_pk_bf16_f32 v236, v236, v237
  v_cvt_pk_bf16_f32 v237, v238, v239
  v_cvt_pk_bf16_f32 v238, v252, v253
  v_cvt_pk_bf16_f32 v239, v254, v255
  v_permlane16_swap_b32 v224, v226
  v_permlane16_swap_b32 v225, v227
  buffer_store_dwordx4 v[224:227], v16, s[28:31], s62 offen offset:0 sc1
  v_permlane16_swap_b32 v228, v230
  v_permlane16_swap_b32 v229, v231
  buffer_store_dwordx4 v[228:231], v16, s[28:31], s62 offen offset:256 sc1
  v_permlane16_swap_b32 v232, v234
  v_permlane16_swap_b32 v233, v235
  buffer_store_dwordx4 v[232:235], v16, s[28:31], s62 offen offset:512 sc1
  v_permlane16_swap_b32 v236, v238
  v_permlane16_swap_b32 v237, v239
  buffer_store_dwordx4 v[236:239], v16, s[28:31], s62 offen offset:768 sc1
  s_mov_b32 s48, 3216550459
  v_mul_f32 v27, s48, v25
  v_mul_f32 v31, s48, v29
  v_mul_f32 v35, s48, v33
  v_mul_f32 v39, s48, v37
  s_lshl_b32 s63, s25, 14
  s_add_u32 s63, s63, s61
  s_add_u32 s64, s63, 8192
  v_pk_fma_f32 v[96:97], v[56:57], v[24:25], v[96:97] op_sel_hi:[1,0,1]
  v_pk_fma_f32 v[98:99], v[58:59], v[24:25], v[98:99] op_sel_hi:[1,0,1]
  v_pk_fma_f32 v[100:101], v[56:57], v[28:29], v[100:101] op_sel_hi:[1,0,1]
  v_pk_fma_f32 v[102:103], v[58:59], v[28:29], v[102:103] op_sel_hi:[1,0,1]
  v_pk_fma_f32 v[104:105], v[56:57], v[32:33], v[104:105] op_sel_hi:[1,0,1]
  v_pk_fma_f32 v[106:107], v[58:59], v[32:33], v[106:107] op_sel_hi:[1,0,1]
  v_pk_fma_f32 v[108:109], v[56:57], v[36:37], v[108:109] op_sel_hi:[1,0,1]
  v_pk_fma_f32 v[110:111], v[58:59], v[36:37], v[110:111] op_sel_hi:[1,0,1]
  v_pk_fma_f32 v[160:161], v[72:73], v[24:25], v[160:161] op_sel_hi:[1,0,1]
  v_pk_fma_f32 v[162:163], v[74:75], v[24:25], v[162:163] op_sel_hi:[1,0,1]
  v_pk_fma_f32 v[164:165], v[72:73], v[28:29], v[164:165] op_sel_hi:[1,0,1]
  v_pk_fma_f32 v[166:167], v[74:75], v[28:29], v[166:167] op_sel_hi:[1,0,1]
  v_pk_fma_f32 v[168:169], v[72:73], v[32:33], v[168:169] op_sel_hi:[1,0,1]
  v_pk_fma_f32 v[170:171], v[74:75], v[32:33], v[170:171] op_sel_hi:[1,0,1]
  v_pk_fma_f32 v[172:173], v[72:73], v[36:37], v[172:173] op_sel_hi:[1,0,1]
  v_pk_fma_f32 v[174:175], v[74:75], v[36:37], v[174:175] op_sel_hi:[1,0,1]
  v_pk_fma_f32 v[112:113], v[60:61], v[24:25], v[112:113] op_sel_hi:[1,0,1]
  v_pk_fma_f32 v[114:115], v[62:63], v[24:25], v[114:115] op_sel_hi:[1,0,1]
  v_pk_fma_f32 v[116:117], v[60:61], v[28:29], v[116:117] op_sel_hi:[1,0,1]
  v_pk_fma_f32 v[118:119], v[62:63], v[28:29], v[118:119] op_sel_hi:[1,0,1]
  v_pk_fma_f32 v[120:121], v[60:61], v[32:33], v[120:121] op_sel_hi:[1,0,1]
  v_pk_fma_f32 v[122:123], v[62:63], v[32:33], v[122:123] op_sel_hi:[1,0,1]
  v_pk_fma_f32 v[124:125], v[60:61], v[36:37], v[124:125] op_sel_hi:[1,0,1]
  v_pk_fma_f32 v[126:127], v[62:63], v[36:37], v[126:127] op_sel_hi:[1,0,1]
  v_pk_fma_f32 v[176:177], v[76:77], v[24:25], v[176:177] op_sel_hi:[1,0,1]
  v_pk_fma_f32 v[178:179], v[78:79], v[24:25], v[178:179] op_sel_hi:[1,0,1]
  v_pk_fma_f32 v[180:181], v[76:77], v[28:29], v[180:181] op_sel_hi:[1,0,1]
  v_pk_fma_f32 v[182:183], v[78:79], v[28:29], v[182:183] op_sel_hi:[1,0,1]
  v_pk_fma_f32 v[184:185], v[76:77], v[32:33], v[184:185] op_sel_hi:[1,0,1]
  v_pk_fma_f32 v[186:187], v[78:79], v[32:33], v[186:187] op_sel_hi:[1,0,1]
  v_pk_fma_f32 v[188:189], v[76:77], v[36:37], v[188:189] op_sel_hi:[1,0,1]
  v_pk_fma_f32 v[190:191], v[78:79], v[36:37], v[190:191] op_sel_hi:[1,0,1]
  v_pk_mul_f32 v[96:97], v[96:97], v[26:27] op_sel:[0,1] op_sel_hi:[1,1]
  v_pk_mul_f32 v[98:99], v[98:99], v[26:27] op_sel:[0,1] op_sel_hi:[1,1]
  v_pk_mul_f32 v[112:113], v[112:113], v[26:27] op_sel:[0,1] op_sel_hi:[1,1]
  v_pk_mul_f32 v[114:115], v[114:115], v[26:27] op_sel:[0,1] op_sel_hi:[1,1]
  v_pk_mul_f32 v[100:101], v[100:101], v[30:31] op_sel:[0,1] op_sel_hi:[1,1]
  v_pk_mul_f32 v[102:103], v[102:103], v[30:31] op_sel:[0,1] op_sel_hi:[1,1]
  v_pk_mul_f32 v[116:117], v[116:117], v[30:31] op_sel:[0,1] op_sel_hi:[1,1]
  v_pk_mul_f32 v[118:119], v[118:119], v[30:31] op_sel:[0,1] op_sel_hi:[1,1]
  v_pk_mul_f32 v[104:105], v[104:105], v[34:35] op_sel:[0,1] op_sel_hi:[1,1]
  v_pk_mul_f32 v[106:107], v[106:107], v[34:35] op_sel:[0,1] op_sel_hi:[1,1]
  v_pk_mul_f32 v[120:121], v[120:121], v[34:35] op_sel:[0,1] op_sel_hi:[1,1]
  v_pk_mul_f32 v[122:123], v[122:123], v[34:35] op_sel:[0,1] op_sel_hi:[1,1]
  v_pk_mul_f32 v[108:109], v[108:109], v[38:39] op_sel:[0,1] op_sel_hi:[1,1]
  v_pk_mul_f32 v[110:111], v[110:111], v[38:39] op_sel:[0,1] op_sel_hi:[1,1]
  v_pk_mul_f32 v[124:125], v[124:125], v[38:39] op_sel:[0,1] op_sel_hi:[1,1]
  v_pk_mul_f32 v[126:127], v[126:127], v[38:39] op_sel:[0,1] op_sel_hi:[1,1]
  v_exp_f32 v96, v96
  v_exp_f32 v97, v97
  v_exp_f32 v98, v98
  v_exp_f32 v99, v99
  v_exp_f32 v112, v112
  v_exp_f32 v113, v113
  v_exp_f32 v114, v114
  v_exp_f32 v115, v115
  v_exp_f32 v100, v100
  v_exp_f32 v101, v101
  v_exp_f32 v102, v102
  v_exp_f32 v103, v103
  v_exp_f32 v116, v116
  v_exp_f32 v117, v117
  v_exp_f32 v118, v118
  v_exp_f32 v119, v119
  v_exp_f32 v104, v104
  v_exp_f32 v105, v105
  v_exp_f32 v106, v106
  v_exp_f32 v107, v107
  v_exp_f32 v120, v120
  v_exp_f32 v121, v121
  v_exp_f32 v122, v122
  v_exp_f32 v123, v123
  v_exp_f32 v108, v108
  v_exp_f32 v109, v109
  v_exp_f32 v110, v110
  v_exp_f32 v111, v111
  v_exp_f32 v124, v124
  v_exp_f32 v125, v125
  v_exp_f32 v126, v126
  v_exp_f32 v127, v127
  v_pk_fma_f32 v[96:97], v[96:97], v[26:27], v[26:27] op_sel_hi:[1,0,0]
  v_pk_fma_f32 v[98:99], v[98:99], v[26:27], v[26:27] op_sel_hi:[1,0,0]
  v_pk_fma_f32 v[112:113], v[112:113], v[26:27], v[26:27] op_sel_hi:[1,0,0]
  v_pk_fma_f32 v[114:115], v[114:115], v[26:27], v[26:27] op_sel_hi:[1,0,0]
  v_pk_fma_f32 v[100:101], v[100:101], v[30:31], v[30:31] op_sel_hi:[1,0,0]
  v_pk_fma_f32 v[102:103], v[102:103], v[30:31], v[30:31] op_sel_hi:[1,0,0]
  v_pk_fma_f32 v[116:117], v[116:117], v[30:31], v[30:31] op_sel_hi:[1,0,0]
  v_pk_fma_f32 v[118:119], v[118:119], v[30:31], v[30:31] op_sel_hi:[1,0,0]
  v_pk_fma_f32 v[104:105], v[104:105], v[34:35], v[34:35] op_sel_hi:[1,0,0]
  v_pk_fma_f32 v[106:107], v[106:107], v[34:35], v[34:35] op_sel_hi:[1,0,0]
  v_pk_fma_f32 v[120:121], v[120:121], v[34:35], v[34:35] op_sel_hi:[1,0,0]
  v_pk_fma_f32 v[122:123], v[122:123], v[34:35], v[34:35] op_sel_hi:[1,0,0]
  v_pk_fma_f32 v[108:109], v[108:109], v[38:39], v[38:39] op_sel_hi:[1,0,0]
  v_pk_fma_f32 v[110:111], v[110:111], v[38:39], v[38:39] op_sel_hi:[1,0,0]
  v_pk_fma_f32 v[124:125], v[124:125], v[38:39], v[38:39] op_sel_hi:[1,0,0]
  v_pk_fma_f32 v[126:127], v[126:127], v[38:39], v[38:39] op_sel_hi:[1,0,0]
  v_rcp_f32 v96, v96
  v_rcp_f32 v97, v97
  v_rcp_f32 v98, v98
  v_rcp_f32 v99, v99
  v_rcp_f32 v112, v112
  v_rcp_f32 v113, v113
  v_rcp_f32 v114, v114
  v_rcp_f32 v115, v115
  v_rcp_f32 v100, v100
  v_rcp_f32 v101, v101
  v_rcp_f32 v102, v102
  v_rcp_f32 v103, v103
  v_rcp_f32 v116, v116
  v_rcp_f32 v117, v117
  v_rcp_f32 v118, v118
  v_rcp_f32 v119, v119
  v_rcp_f32 v104, v104
  v_rcp_f32 v105, v105
  v_rcp_f32 v106, v106
  v_rcp_f32 v107, v107
  v_rcp_f32 v120, v120
  v_rcp_f32 v121, v121
  v_rcp_f32 v122, v122
  v_rcp_f32 v123, v123
  v_rcp_f32 v108, v108
  v_rcp_f32 v109, v109
  v_rcp_f32 v110, v110
  v_rcp_f32 v111, v111
  v_rcp_f32 v124, v124
  v_rcp_f32 v125, v125
  v_rcp_f32 v126, v126
  v_rcp_f32 v127, v127
  v_pk_mul_f32 v[96:97], v[96:97], v[160:161]
  v_pk_mul_f32 v[98:99], v[98:99], v[162:163]
  v_pk_mul_f32 v[112:113], v[112:113], v[176:177]
  v_pk_mul_f32 v[114:115], v[114:115], v[178:179]
  v_pk_mul_f32 v[100:101], v[100:101], v[164:165]
  v_pk_mul_f32 v[102:103], v[102:103], v[166:167]
  v_pk_mul_f32 v[116:117], v[116:117], v[180:181]
  v_pk_mul_f32 v[118:119], v[118:119], v[182:183]
  v_pk_mul_f32 v[104:105], v[104:105], v[168:169]
  v_pk_mul_f32 v[106:107], v[106:107], v[170:171]
  v_pk_mul_f32 v[120:121], v[120:121], v[184:185]
  v_pk_mul_f32 v[122:123], v[122:123], v[186:187]
  v_pk_mul_f32 v[108:109], v[108:109], v[172:173]
  v_pk_mul_f32 v[110:111], v[110:111], v[174:175]
  v_pk_mul_f32 v[124:125], v[124:125], v[188:189]
  v_pk_mul_f32 v[126:127], v[126:127], v[190:191]
  v_cvt_pk_bf16_f32 v96, v96, v97
  v_cvt_pk_bf16_f32 v97, v98, v99
  v_cvt_pk_bf16_f32 v98, v112, v113
  v_cvt_pk_bf16_f32 v99, v114, v115
  v_cvt_pk_bf16_f32 v100, v100, v101
  v_cvt_pk_bf16_f32 v101, v102, v103
  v_cvt_pk_bf16_f32 v102, v116, v117
  v_cvt_pk_bf16_f32 v103, v118, v119
  v_cvt_pk_bf16_f32 v104, v104, v105
  v_cvt_pk_bf16_f32 v105, v106, v107
  v_cvt_pk_bf16_f32 v106, v120, v121
  v_cvt_pk_bf16_f32 v107, v122, v123
  v_cvt_pk_bf16_f32 v108, v108, v109
  v_cvt_pk_bf16_f32 v109, v110, v111
  v_cvt_pk_bf16_f32 v110, v124, v125
  v_cvt_pk_bf16_f32 v111, v126, v127
  s_waitcnt lgkmcnt(0)
  s_waitcnt vmcnt(0)
  v_mov_b32 v18, 1
  s_mov_b64 exec, 1
  ds_add_rtn_u32 v18, v19, v18
  s_mov_b64 exec, -1
  s_waitcnt lgkmcnt(0)
  v_readfirstlane_b32 s48, v18
  s_cmp_lg_u32 s48, 3
  s_cbranch_scc1 L_fa_30
  s_mov_b64 exec, 1
  buffer_store_dword v23, v17, s[28:31], s67 offen sc1
  s_mov_b64 exec, -1
L_fa_30:
  v_permlane16_swap_b32 v96, v98
  v_permlane16_swap_b32 v97, v99
  buffer_store_dwordx4 v[96:99], v16, s[28:31], s63 offen offset:0 sc1
  v_permlane16_swap_b32 v100, v102
  v_permlane16_swap_b32 v101, v103
  buffer_store_dwordx4 v[100:103], v16, s[28:31], s63 offen offset:256 sc1
  v_permlane16_swap_b32 v104, v106
  v_permlane16_swap_b32 v105, v107
  buffer_store_dwordx4 v[104:107], v16, s[28:31], s63 offen offset:512 sc1
  v_permlane16_swap_b32 v108, v110
  v_permlane16_swap_b32 v109, v111
  buffer_store_dwordx4 v[108:111], v16, s[28:31], s63 offen offset:768 sc1
  v_pk_fma_f32 v[128:129], v[64:65], v[24:25], v[128:129] op_sel_hi:[1,0,1]
  v_pk_fma_f32 v[130:131], v[66:67], v[24:25], v[130:131] op_sel_hi:[1,0,1]
  v_pk_fma_f32 v[132:133], v[64:65], v[28:29], v[132:133] op_sel_hi:[1,0,1]
  v_pk_fma_f32 v[134:135], v[66:67], v[28:29], v[134:135] op_sel_hi:[1,0,1]
  v_pk_fma_f32 v[136:137], v[64:65], v[32:33], v[136:137] op_sel_hi:[1,0,1]
  v_pk_fma_f32 v[138:139], v[66:67], v[32:33], v[138:139] op_sel_hi:[1,0,1]
  v_pk_fma_f32 v[140:141], v[64:65], v[36:37], v[140:141] op_sel_hi:[1,0,1]
  v_pk_fma_f32 v[142:143], v[66:67], v[36:37], v[142:143] op_sel_hi:[1,0,1]
  v_pk_fma_f32 v[192:193], v[80:81], v[24:25], v[192:193] op_sel_hi:[1,0,1]
  v_pk_fma_f32 v[194:195], v[82:83], v[24:25], v[194:195] op_sel_hi:[1,0,1]
  v_pk_fma_f32 v[196:197], v[80:81], v[28:29], v[196:197] op_sel_hi:[1,0,1]
  v_pk_fma_f32 v[198:199], v[82:83], v[28:29], v[198:199] op_sel_hi:[1,0,1]
  v_pk_fma_f32 v[200:201], v[80:81], v[32:33], v[200:201] op_sel_hi:[1,0,1]
  v_pk_fma_f32 v[202:203], v[82:83], v[32:33], v[202:203] op_sel_hi:[1,0,1]
  v_pk_fma_f32 v[204:205], v[80:81], v[36:37], v[204:205] op_sel_hi:[1,0,1]
  v_pk_fma_f32 v[206:207], v[82:83], v[36:37], v[206:207] op_sel_hi:[1,0,1]
  v_pk_fma_f32 v[144:145], v[68:69], v[24:25], v[144:145] op_sel_hi:[1,0,1]
  v_pk_fma_f32 v[146:147], v[70:71], v[24:25], v[146:147] op_sel_hi:[1,0,1]
  v_pk_fma_f32 v[148:149], v[68:69], v[28:29], v[148:149] op_sel_hi:[1,0,1]
  v_pk_fma_f32 v[150:151], v[70:71], v[28:29], v[150:151] op_sel_hi:[1,0,1]
  v_pk_fma_f32 v[152:153], v[68:69], v[32:33], v[152:153] op_sel_hi:[1,0,1]
  v_pk_fma_f32 v[154:155], v[70:71], v[32:33], v[154:155] op_sel_hi:[1,0,1]
  v_pk_fma_f32 v[156:157], v[68:69], v[36:37], v[156:157] op_sel_hi:[1,0,1]
  v_pk_fma_f32 v[158:159], v[70:71], v[36:37], v[158:159] op_sel_hi:[1,0,1]
  v_pk_fma_f32 v[208:209], v[84:85], v[24:25], v[208:209] op_sel_hi:[1,0,1]
  v_pk_fma_f32 v[210:211], v[86:87], v[24:25], v[210:211] op_sel_hi:[1,0,1]
  v_pk_fma_f32 v[212:213], v[84:85], v[28:29], v[212:213] op_sel_hi:[1,0,1]
  v_pk_fma_f32 v[214:215], v[86:87], v[28:29], v[214:215] op_sel_hi:[1,0,1]
  v_pk_fma_f32 v[216:217], v[84:85], v[32:33], v[216:217] op_sel_hi:[1,0,1]
  v_pk_fma_f32 v[218:219], v[86:87], v[32:33], v[218:219] op_sel_hi:[1,0,1]
  v_pk_fma_f32 v[220:221], v[84:85], v[36:37], v[220:221] op_sel_hi:[1,0,1]
  v_pk_fma_f32 v[222:223], v[86:87], v[36:37], v[222:223] op_sel_hi:[1,0,1]
  v_pk_mul_f32 v[128:129], v[128:129], v[26:27] op_sel:[0,1] op_sel_hi:[1,1]
  v_pk_mul_f32 v[130:131], v[130:131], v[26:27] op_sel:[0,1] op_sel_hi:[1,1]
  v_pk_mul_f32 v[144:145], v[144:145], v[26:27] op_sel:[0,1] op_sel_hi:[1,1]
  v_pk_mul_f32 v[146:147], v[146:147], v[26:27] op_sel:[0,1] op_sel_hi:[1,1]
  v_pk_mul_f32 v[132:133], v[132:133], v[30:31] op_sel:[0,1] op_sel_hi:[1,1]
  v_pk_mul_f32 v[134:135], v[134:135], v[30:31] op_sel:[0,1] op_sel_hi:[1,1]
  v_pk_mul_f32 v[148:149], v[148:149], v[30:31] op_sel:[0,1] op_sel_hi:[1,1]
  v_pk_mul_f32 v[150:151], v[150:151], v[30:31] op_sel:[0,1] op_sel_hi:[1,1]
  v_pk_mul_f32 v[136:137], v[136:137], v[34:35] op_sel:[0,1] op_sel_hi:[1,1]
  v_pk_mul_f32 v[138:139], v[138:139], v[34:35] op_sel:[0,1] op_sel_hi:[1,1]
  v_pk_mul_f32 v[152:153], v[152:153], v[34:35] op_sel:[0,1] op_sel_hi:[1,1]
  v_pk_mul_f32 v[154:155], v[154:155], v[34:35] op_sel:[0,1] op_sel_hi:[1,1]
  v_pk_mul_f32 v[140:141], v[140:141], v[38:39] op_sel:[0,1] op_sel_hi:[1,1]
  v_pk_mul_f32 v[142:143], v[142:143], v[38:39] op_sel:[0,1] op_sel_hi:[1,1]
  v_pk_mul_f32 v[156:157], v[156:157], v[38:39] op_sel:[0,1] op_sel_hi:[1,1]
  v_pk_mul_f32 v[158:159], v[158:159], v[38:39] op_sel:[0,1] op_sel_hi:[1,1]
  v_exp_f32 v128, v128
  v_exp_f32 v129, v129
  v_exp_f32 v130, v130
  v_exp_f32 v131, v131
  v_exp_f32 v144, v144
  v_exp_f32 v145, v145
  v_exp_f32 v146, v146
  v_exp_f32 v147, v147
  v_exp_f32 v132, v132
  v_exp_f32 v133, v133
  v_exp_f32 v134, v134
  v_exp_f32 v135, v135
  v_exp_f32 v148, v148
  v_exp_f32 v149, v149
  v_exp_f32 v150, v150
  v_exp_f32 v151, v151
  v_exp_f32 v136, v136
  v_exp_f32 v137, v137
  v_exp_f32 v138, v138
  v_exp_f32 v139, v139
  v_exp_f32 v152, v152
  v_exp_f32 v153, v153
  v_exp_f32 v154, v154
  v_exp_f32 v155, v155
  v_exp_f32 v140, v140
  v_exp_f32 v141, v141
  v_exp_f32 v142, v142
  v_exp_f32 v143, v143
  v_exp_f32 v156, v156
  v_exp_f32 v157, v157
  v_exp_f32 v158, v158
  v_exp_f32 v159, v159
  v_pk_fma_f32 v[128:129], v[128:129], v[26:27], v[26:27] op_sel_hi:[1,0,0]
  v_pk_fma_f32 v[130:131], v[130:131], v[26:27], v[26:27] op_sel_hi:[1,0,0]
  v_pk_fma_f32 v[144:145], v[144:145], v[26:27], v[26:27] op_sel_hi:[1,0,0]
  v_pk_fma_f32 v[146:147], v[146:147], v[26:27], v[26:27] op_sel_hi:[1,0,0]
  v_pk_fma_f32 v[132:133], v[132:133], v[30:31], v[30:31] op_sel_hi:[1,0,0]
  v_pk_fma_f32 v[134:135], v[134:135], v[30:31], v[30:31] op_sel_hi:[1,0,0]
  v_pk_fma_f32 v[148:149], v[148:149], v[30:31], v[30:31] op_sel_hi:[1,0,0]
  v_pk_fma_f32 v[150:151], v[150:151], v[30:31], v[30:31] op_sel_hi:[1,0,0]
  v_pk_fma_f32 v[136:137], v[136:137], v[34:35], v[34:35] op_sel_hi:[1,0,0]
  v_pk_fma_f32 v[138:139], v[138:139], v[34:35], v[34:35] op_sel_hi:[1,0,0]
  v_pk_fma_f32 v[152:153], v[152:153], v[34:35], v[34:35] op_sel_hi:[1,0,0]
  v_pk_fma_f32 v[154:155], v[154:155], v[34:35], v[34:35] op_sel_hi:[1,0,0]
  v_pk_fma_f32 v[140:141], v[140:141], v[38:39], v[38:39] op_sel_hi:[1,0,0]
  v_pk_fma_f32 v[142:143], v[142:143], v[38:39], v[38:39] op_sel_hi:[1,0,0]
  v_pk_fma_f32 v[156:157], v[156:157], v[38:39], v[38:39] op_sel_hi:[1,0,0]
  v_pk_fma_f32 v[158:159], v[158:159], v[38:39], v[38:39] op_sel_hi:[1,0,0]
  v_rcp_f32 v128, v128
  v_rcp_f32 v129, v129
  v_rcp_f32 v130, v130
  v_rcp_f32 v131, v131
  v_rcp_f32 v144, v144
  v_rcp_f32 v145, v145
  v_rcp_f32 v146, v146
  v_rcp_f32 v147, v147
  v_rcp_f32 v132, v132
  v_rcp_f32 v133, v133
  v_rcp_f32 v134, v134
  v_rcp_f32 v135, v135
  v_rcp_f32 v148, v148
  v_rcp_f32 v149, v149
  v_rcp_f32 v150, v150
  v_rcp_f32 v151, v151
  v_rcp_f32 v136, v136
  v_rcp_f32 v137, v137
  v_rcp_f32 v138, v138
  v_rcp_f32 v139, v139
  v_rcp_f32 v152, v152
  v_rcp_f32 v153, v153
  v_rcp_f32 v154, v154
  v_rcp_f32 v155, v155
  v_rcp_f32 v140, v140
  v_rcp_f32 v141, v141
  v_rcp_f32 v142, v142
  v_rcp_f32 v143, v143
  v_rcp_f32 v156, v156
  v_rcp_f32 v157, v157
  v_rcp_f32 v158, v158
  v_rcp_f32 v159, v159
  v_pk_mul_f32 v[128:129], v[128:129], v[192:193]
  v_pk_mul_f32 v[130:131], v[130:131], v[194:195]
  v_pk_mul_f32 v[144:145], v[144:145], v[208:209]
  v_pk_mul_f32 v[146:147], v[146:147], v[210:211]
  v_pk_mul_f32 v[132:133], v[132:133], v[196:197]
  v_pk_mul_f32 v[134:135], v[134:135], v[198:199]
  v_pk_mul_f32 v[148:149], v[148:149], v[212:213]
  v_pk_mul_f32 v[150:151], v[150:151], v[214:215]
  v_pk_mul_f32 v[136:137], v[136:137], v[200:201]
  v_pk_mul_f32 v[138:139], v[138:139], v[202:203]
  v_pk_mul_f32 v[152:153], v[152:153], v[216:217]
  v_pk_mul_f32 v[154:155], v[154:155], v[218:219]
  v_pk_mul_f32 v[140:141], v[140:141], v[204:205]
  v_pk_mul_f32 v[142:143], v[142:143], v[206:207]
  v_pk_mul_f32 v[156:157], v[156:157], v[220:221]
  v_pk_mul_f32 v[158:159], v[158:159], v[222:223]
  v_cvt_pk_bf16_f32 v128, v128, v129
  v_cvt_pk_bf16_f32 v129, v130, v131
  v_cvt_pk_bf16_f32 v130, v144, v145
  v_cvt_pk_bf16_f32 v131, v146, v147
  v_cvt_pk_bf16_f32 v132, v132, v133
  v_cvt_pk_bf16_f32 v133, v134, v135
  v_cvt_pk_bf16_f32 v134, v148, v149
  v_cvt_pk_bf16_f32 v135, v150, v151
  v_cvt_pk_bf16_f32 v136, v136, v137
  v_cvt_pk_bf16_f32 v137, v138, v139
  v_cvt_pk_bf16_f32 v138, v152, v153
  v_cvt_pk_bf16_f32 v139, v154, v155
  v_cvt_pk_bf16_f32 v140, v140, v141
  v_cvt_pk_bf16_f32 v141, v142, v143
  v_cvt_pk_bf16_f32 v142, v156, v157
  v_cvt_pk_bf16_f32 v143, v158, v159
  v_permlane16_swap_b32 v128, v130
  v_permlane16_swap_b32 v129, v131
  buffer_store_dwordx4 v[128:131], v16, s[28:31], s64 offen offset:0 sc1
  v_permlane16_swap_b32 v132, v134
  v_permlane16_swap_b32 v133, v135
  buffer_store_dwordx4 v[132:135], v16, s[28:31], s64 offen offset:256 sc1
  v_permlane16_swap_b32 v136, v138
  v_permlane16_swap_b32 v137, v139
  buffer_store_dwordx4 v[136:139], v16, s[28:31], s64 offen offset:512 sc1
  v_permlane16_swap_b32 v140, v142
  v_permlane16_swap_b32 v141, v143
  buffer_store_dwordx4 v[140:143], v16, s[28:31], s64 offen offset:768 sc1
  s_branch L_epi_done
L_epi_b:
  s_lshl_b32 s62, s83, 13
  s_add_u32 s62, s62, s60
  s_add_u32 s63, s62, 8192
  s_add_u32 s64, s62, 16384
  s_cmp_eq_u32 s25, 15
  s_cselect_b32 s62, 1073741824, s62
  s_cselect_b32 s63, 1073741824, s63
  s_mov_b32 s48, 1051011932
  s_cmp_lt_u32 s83, 10
  s_cselect_b32 s48, s48, 1.0
  s_waitcnt lgkmcnt(14)
  v_mul_f32 v27, s48, v25
  s_waitcnt lgkmcnt(13)
  v_mul_f32 v31, s48, v29
  s_waitcnt lgkmcnt(12)
  v_mul_f32 v35, s48, v33
  s_waitcnt lgkmcnt(11)
  v_mul_f32 v39, s48, v37
  s_nop 4
  s_waitcnt lgkmcnt(10)
  v_pk_fma_f32 v[96:97], v[56:57], v[24:25], v[96:97] op_sel_hi:[1,0,1]
  v_pk_fma_f32 v[98:99], v[58:59], v[24:25], v[98:99] op_sel_hi:[1,0,1]
  v_pk_fma_f32 v[100:101], v[56:57], v[28:29], v[100:101] op_sel_hi:[1,0,1]
  v_pk_fma_f32 v[102:103], v[58:59], v[28:29], v[102:103] op_sel_hi:[1,0,1]
  v_pk_fma_f32 v[104:105], v[56:57], v[32:33], v[104:105] op_sel_hi:[1,0,1]
  v_pk_fma_f32 v[106:107], v[58:59], v[32:33], v[106:107] op_sel_hi:[1,0,1]
  v_pk_fma_f32 v[108:109], v[56:57], v[36:37], v[108:109] op_sel_hi:[1,0,1]
  v_pk_fma_f32 v[110:111], v[58:59], v[36:37], v[110:111] op_sel_hi:[1,0,1]
  s_waitcnt lgkmcnt(9)
  v_pk_fma_f32 v[112:113], v[60:61], v[24:25], v[112:113] op_sel_hi:[1,0,1]
  v_pk_fma_f32 v[114:115], v[62:63], v[24:25], v[114:115] op_sel_hi:[1,0,1]
  v_pk_fma_f32 v[116:117], v[60:61], v[28:29], v[116:117] op_sel_hi:[1,0,1]
  v_pk_fma_f32 v[118:119], v[62:63], v[28:29], v[118:119] op_sel_hi:[1,0,1]
  v_pk_fma_f32 v[120:121], v[60:61], v[32:33], v[120:121] op_sel_hi:[1,0,1]
  v_pk_fma_f32 v[122:123], v[62:63], v[32:33], v[122:123] op_sel_hi:[1,0,1]
  v_pk_fma_f32 v[124:125], v[60:61], v[36:37], v[124:125] op_sel_hi:[1,0,1]
  v_pk_fma_f32 v[126:127], v[62:63], v[36:37], v[126:127] op_sel_hi:[1,0,1]
  v_pk_mul_f32 v[96:97], v[96:97], v[26:27] op_sel:[0,1] op_sel_hi:[1,1]
  v_pk_mul_f32 v[98:99], v[98:99], v[26:27] op_sel:[0,1] op_sel_hi:[1,1]
  v_pk_mul_f32 v[112:113], v[112:113], v[26:27] op_sel:[0,1] op_sel_hi:[1,1]
  v_pk_mul_f32 v[114:115], v[114:115], v[26:27] op_sel:[0,1] op_sel_hi:[1,1]
  v_pk_mul_f32 v[100:101], v[100:101], v[30:31] op_sel:[0,1] op_sel_hi:[1,1]
  v_pk_mul_f32 v[102:103], v[102:103], v[30:31] op_sel:[0,1] op_sel_hi:[1,1]
  v_pk_mul_f32 v[116:117], v[116:117], v[30:31] op_sel:[0,1] op_sel_hi:[1,1]
  v_pk_mul_f32 v[118:119], v[118:119], v[30:31] op_sel:[0,1] op_sel_hi:[1,1]
  v_pk_mul_f32 v[104:105], v[104:105], v[34:35] op_sel:[0,1] op_sel_hi:[1,1]
  v_pk_mul_f32 v[106:107], v[106:107], v[34:35] op_sel:[0,1] op_sel_hi:[1,1]
  v_pk_mul_f32 v[120:121], v[120:121], v[34:35] op_sel:[0,1] op_sel_hi:[1,1]
  v_pk_mul_f32 v[122:123], v[122:123], v[34:35] op_sel:[0,1] op_sel_hi:[1,1]
  v_pk_mul_f32 v[108:109], v[108:109], v[38:39] op_sel:[0,1] op_sel_hi:[1,1]
  v_pk_mul_f32 v[110:111], v[110:111], v[38:39] op_sel:[0,1] op_sel_hi:[1,1]
  v_pk_mul_f32 v[124:125], v[124:125], v[38:39] op_sel:[0,1] op_sel_hi:[1,1]
  v_pk_mul_f32 v[126:127], v[126:127], v[38:39] op_sel:[0,1] op_sel_hi:[1,1]
  v_cvt_pk_bf16_f32 v96, v96, v97
  v_cvt_pk_bf16_f32 v97, v98, v99
  v_cvt_pk_bf16_f32 v98, v112, v113
  v_cvt_pk_bf16_f32 v99, v114, v115
  v_cvt_pk_bf16_f32 v100, v100, v101
  v_cvt_pk_bf16_f32 v101, v102, v103
  v_cvt_pk_bf16_f32 v102, v116, v117
  v_cvt_pk_bf16_f32 v103, v118, v119
  v_cvt_pk_bf16_f32 v104, v104, v105
  v_cvt_pk_bf16_f32 v105, v106, v107
  v_cvt_pk_bf16_f32 v106, v120, v121
  v_cvt_pk_bf16_f32 v107, v122, v123
  v_cvt_pk_bf16_f32 v108, v108, v109
  v_cvt_pk_bf16_f32 v109, v110, v111
  v_cvt_pk_bf16_f32 v110, v124, v125
  v_cvt_pk_bf16_f32 v111, v126, v127
  v_permlane16_swap_b32 v96, v98
  v_permlane16_swap_b32 v97, v99
  buffer_store_dwordx4 v[96:99], v16, s[28:31], s62 offen offset:0 sc1
  v_permlane16_swap_b32 v100, v102
  v_permlane16_swap_b32 v101, v103
  buffer_store_dwordx4 v[100:103], v16, s[28:31], s62 offen offset:256 sc1
  v_permlane16_swap_b32 v104, v106
  v_permlane16_swap_b32 v105, v107
  buffer_store_dwordx4 v[104:107], v16, s[28:31], s62 offen offset:512 sc1
  v_permlane16_swap_b32 v108, v110
  v_permlane16_swap_b32 v109, v111
  buffer_store_dwordx4 v[108:111], v16, s[28:31], s62 offen offset:768 sc1
  s_waitcnt lgkmcnt(8)
  v_pk_fma_f32 v[128:129], v[64:65], v[24:25], v[128:129] op_sel_hi:[1,0,1]
  v_pk_fma_f32 v[130:131], v[66:67], v[24:25], v[130:131] op_sel_hi:[1,0,1]
  v_pk_fma_f32 v[132:133], v[64:65], v[28:29], v[132:133] op_sel_hi:[1,0,1]
  v_pk_fma_f32 v[134:135], v[66:67], v[28:29], v[134:135] op_sel_hi:[1,0,1]
  v_pk_fma_f32 v[136:137], v[64:65], v[32:33], v[136:137] op_sel_hi:[1,0,1]
  v_pk_fma_f32 v[138:139], v[66:67], v[32:33], v[138:139] op_sel_hi:[1,0,1]
  v_pk_fma_f32 v[140:141], v[64:65], v[36:37], v[140:141] op_sel_hi:[1,0,1]
  v_pk_fma_f32 v[142:143], v[66:67], v[36:37], v[142:143] op_sel_hi:[1,0,1]
  s_waitcnt lgkmcnt(7)
  v_pk_fma_f32 v[144:145], v[68:69], v[24:25], v[144:145] op_sel_hi:[1,0,1]
  v_pk_fma_f32 v[146:147], v[70:71], v[24:25], v[146:147] op_sel_hi:[1,0,1]
  v_pk_fma_f32 v[148:149], v[68:69], v[28:29], v[148:149] op_sel_hi:[1,0,1]
  v_pk_fma_f32 v[150:151], v[70:71], v[28:29], v[150:151] op_sel_hi:[1,0,1]
  v_pk_fma_f32 v[152:153], v[68:69], v[32:33], v[152:153] op_sel_hi:[1,0,1]
  v_pk_fma_f32 v[154:155], v[70:71], v[32:33], v[154:155] op_sel_hi:[1,0,1]
  v_pk_fma_f32 v[156:157], v[68:69], v[36:37], v[156:157] op_sel_hi:[1,0,1]
  v_pk_fma_f32 v[158:159], v[70:71], v[36:37], v[158:159] op_sel_hi:[1,0,1]
  v_pk_mul_f32 v[128:129], v[128:129], v[26:27] op_sel:[0,1] op_sel_hi:[1,1]
  v_pk_mul_f32 v[130:131], v[130:131], v[26:27] op_sel:[0,1] op_sel_hi:[1,1]
  v_pk_mul_f32 v[144:145], v[144:145], v[26:27] op_sel:[0,1] op_sel_hi:[1,1]
  v_pk_mul_f32 v[146:147], v[146:147], v[26:27] op_sel:[0,1] op_sel_hi:[1,1]
  v_pk_mul_f32 v[132:133], v[132:133], v[30:31] op_sel:[0,1] op_sel_hi:[1,1]
  v_pk_mul_f32 v[134:135], v[134:135], v[30:31] op_sel:[0,1] op_sel_hi:[1,1]
  v_pk_mul_f32 v[148:149], v[148:149], v[30:31] op_sel:[0,1] op_sel_hi:[1,1]
  v_pk_mul_f32 v[150:151], v[150:151], v[30:31] op_sel:[0,1] op_sel_hi:[1,1]
  v_pk_mul_f32 v[136:137], v[136:137], v[34:35] op_sel:[0,1] op_sel_hi:[1,1]
  v_pk_mul_f32 v[138:139], v[138:139], v[34:35] op_sel:[0,1] op_sel_hi:[1,1]
  v_pk_mul_f32 v[152:153], v[152:153], v[34:35] op_sel:[0,1] op_sel_hi:[1,1]
  v_pk_mul_f32 v[154:155], v[154:155], v[34:35] op_sel:[0,1] op_sel_hi:[1,1]
  v_pk_mul_f32 v[140:141], v[140:141], v[38:39] op_sel:[0,1] op_sel_hi:[1,1]
  v_pk_mul_f32 v[142:143], v[142:143], v[38:39] op_sel:[0,1] op_sel_hi:[1,1]
  v_pk_mul_f32 v[156:157], v[156:157], v[38:39] op_sel:[0,1] op_sel_hi:[1,1]
  v_pk_mul_f32 v[158:159], v[158:159], v[38:39] op_sel:[0,1] op_sel_hi:[1,1]
  v_cvt_pk_bf16_f32 v128, v128, v129
  v_cvt_pk_bf16_f32 v129, v130, v131
  v_cvt_pk_bf16_f32 v130, v144, v145
  v_cvt_pk_bf16_f32 v131, v146, v147
  v_cvt_pk_bf16_f32 v132, v132, v133
  v_cvt_pk_bf16_f32 v133, v134, v135
  v_cvt_pk_bf16_f32 v134, v148, v149
  v_cvt_pk_bf16_f32 v135, v150, v151
  v_cvt_pk_bf16_f32 v136, v136, v137
  v_cvt_pk_bf16_f32 v137, v138, v139
  v_cvt_pk_bf16_f32 v138, v152, v153
  v_cvt_pk_bf16_f32 v139, v154, v155
  v_cvt_pk_bf16_f32 v140, v140, v141
  v_cvt_pk_bf16_f32 v141, v142, v143
  v_cvt_pk_bf16_f32 v142, v156, v157
  v_cvt_pk_bf16_f32 v143, v158, v159
  v_permlane16_swap_b32 v128, v130
  v_permlane16_swap_b32 v129, v131
  buffer_store_dwordx4 v[128:131], v16, s[28:31], s63 offen offset:0 sc1
  v_permlane16_swap_b32 v132, v134
  v_permlane16_swap_b32 v133, v135
  buffer_store_dwordx4 v[132:135], v16, s[28:31], s63 offen offset:256 sc1
  v_permlane16_swap_b32 v136, v138
  v_permlane16_swap_b32 v137, v139
  buffer_store_dwordx4 v[136:139], v16, s[28:31], s63 offen offset:512 sc1
  v_permlane16_swap_b32 v140, v142
  v_permlane16_swap_b32 v141, v143
  buffer_store_dwordx4 v[140:143], v16, s[28:31], s63 offen offset:768 sc1
  s_waitcnt lgkmcnt(2)
  v_pk_fma_f32 v[224:225], v[88:89], v[24:25], v[224:225] op_sel_hi:[1,0,1]
  v_pk_fma_f32 v[226:227], v[90:91], v[24:25], v[226:227] op_sel_hi:[1,0,1]
  v_pk_fma_f32 v[228:229], v[88:89], v[28:29], v[228:229] op_sel_hi:[1,0,1]
  v_pk_fma_f32 v[230:231], v[90:91], v[28:29], v[230:231] op_sel_hi:[1,0,1]
  v_pk_fma_f32 v[232:233], v[88:89], v[32:33], v[232:233] op_sel_hi:[1,0,1]
  v_pk_fma_f32 v[234:235], v[90:91], v[32:33], v[234:235] op_sel_hi:[1,0,1]
  v_pk_fma_f32 v[236:237], v[88:89], v[36:37], v[236:237] op_sel_hi:[1,0,1]
  v_pk_fma_f32 v[238:239], v[90:91], v[36:37], v[238:239] op_sel_hi:[1,0,1]
  s_waitcnt lgkmcnt(1)
  v_pk_fma_f32 v[240:241], v[92:93], v[24:25], v[240:241] op_sel_hi:[1,0,1]
  v_pk_fma_f32 v[242:243], v[94:95], v[24:25], v[242:243] op_sel_hi:[1,0,1]
  v_pk_fma_f32 v[244:245], v[92:93], v[28:29], v[244:245] op_sel_hi:[1,0,1]
  v_pk_fma_f32 v[246:247], v[94:95], v[28:29], v[246:247] op_sel_hi:[1,0,1]
  v_pk_fma_f32 v[248:249], v[92:93], v[32:33], v[248:249] op_sel_hi:[1,0,1]
  v_pk_fma_f32 v[250:251], v[94:95], v[32:33], v[250:251] op_sel_hi:[1,0,1]
  v_pk_fma_f32 v[252:253], v[92:93], v[36:37], v[252:253] op_sel_hi:[1,0,1]
  v_pk_fma_f32 v[254:255], v[94:95], v[36:37], v[254:255] op_sel_hi:[1,0,1]
  v_pk_mul_f32 v[224:225], v[224:225], v[24:25] op_sel:[0,1] op_sel_hi:[1,1]
  v_pk_mul_f32 v[226:227], v[226:227], v[24:25] op_sel:[0,1] op_sel_hi:[1,1]
  v_pk_mul_f32 v[240:241], v[240:241], v[24:25] op_sel:[0,1] op_sel_hi:[1,1]
  v_pk_mul_f32 v[242:243], v[242:243], v[24:25] op_sel:[0,1] op_sel_hi:[1,1]
  v_pk_mul_f32 v[228:229], v[228:229], v[28:29] op_sel:[0,1] op_sel_hi:[1,1]
  v_pk_mul_f32 v[230:231], v[230:231], v[28:29] op_sel:[0,1] op_sel_hi:[1,1]
  v_pk_mul_f32 v[244:245], v[244:245], v[28:29] op_sel:[0,1] op_sel_hi:[1,1]
  v_pk_mul_f32 v[246:247], v[246:247], v[28:29] op_sel:[0,1] op_sel_hi:[1,1]
  v_pk_mul_f32 v[232:233], v[232:233], v[32:33] op_sel:[0,1] op_sel_hi:[1,1]
  v_pk_mul_f32 v[234:235], v[234:235], v[32:33] op_sel:[0,1] op_sel_hi:[1,1]
  v_pk_mul_f32 v[248:249], v[248:249], v[32:33] op_sel:[0,1] op_sel_hi:[1,1]
  v_pk_mul_f32 v[250:251], v[250:251], v[32:33] op_sel:[0,1] op_sel_hi:[1,1]
  v_pk_mul_f32 v[236:237], v[236:237], v[36:37] op_sel:[0,1] op_sel_hi:[1,1]
  v_pk_mul_f32 v[238:239], v[238:239], v[36:37] op_sel:[0,1] op_sel_hi:[1,1]
  v_pk_mul_f32 v[252:253], v[252:253], v[36:37] op_sel:[0,1] op_sel_hi:[1,1]
  v_pk_mul_f32 v[254:255], v[254:255], v[36:37] op_sel:[0,1] op_sel_hi:[1,1]
  v_cvt_pk_bf16_f32 v224, v224, v225
  v_cvt_pk_bf16_f32 v225, v226, v227
  v_cvt_pk_bf16_f32 v226, v240, v241
  v_cvt_pk_bf16_f32 v227, v242, v243
  v_cvt_pk_bf16_f32 v228, v228, v229
  v_cvt_pk_bf16_f32 v229, v230, v231
  v_cvt_pk_bf16_f32 v230, v244, v245
  v_cvt_pk_bf16_f32 v231, v246, v247
  v_cvt_pk_bf16_f32 v232, v232, v233
  v_cvt_pk_bf16_f32 v233, v234, v235
  v_cvt_pk_bf16_f32 v234, v248, v249
  v_cvt_pk_bf16_f32 v235, v250, v251
  v_cvt_pk_bf16_f32 v236, v236, v237
  v_cvt_pk_bf16_f32 v237, v238, v239
  v_cvt_pk_bf16_f32 v238, v252, v253
  v_cvt_pk_bf16_f32 v239, v254, v255
  v_permlane16_swap_b32 v224, v226
  v_permlane16_swap_b32 v225, v227
  buffer_store_dwordx4 v[224:227], v16, s[28:31], s64 offen offset:0 sc1
  v_permlane16_swap_b32 v228, v230
  v_permlane16_swap_b32 v229, v231
  buffer_store_dwordx4 v[228:231], v16, s[28:31], s64 offen offset:256 sc1
  v_permlane16_swap_b32 v232, v234
  v_permlane16_swap_b32 v233, v235
  buffer_store_dwordx4 v[232:235], v16, s[28:31], s64 offen offset:512 sc1
  v_permlane16_swap_b32 v236, v238
  v_permlane16_swap_b32 v237, v239
  buffer_store_dwordx4 v[236:239], v16, s[28:31], s64 offen offset:768 sc1
  s_mov_b32 s48, 3216550459
  v_mul_f32 v27, s48, v25
  v_mul_f32 v31, s48, v29
  v_mul_f32 v35, s48, v33
  v_mul_f32 v39, s48, v37
  s_and_b32 s65, s25, 7
  s_lshl_b32 s65, s65, 13
  s_add_u32 s65, s65, 131072
  s_add_u32 s65, s65, s61
  v_pk_fma_f32 v[160:161], v[72:73], v[24:25], v[160:161] op_sel_hi:[1,0,1]
  v_pk_fma_f32 v[162:163], v[74:75], v[24:25], v[162:163] op_sel_hi:[1,0,1]
  v_pk_fma_f32 v[164:165], v[72:73], v[28:29], v[164:165] op_sel_hi:[1,0,1]
  v_pk_fma_f32 v[166:167], v[74:75], v[28:29], v[166:167] op_sel_hi:[1,0,1]
  v_pk_fma_f32 v[168:169], v[72:73], v[32:33], v[168:169] op_sel_hi:[1,0,1]
  v_pk_fma_f32 v[170:171], v[74:75], v[32:33], v[170:171] op_sel_hi:[1,0,1]
  v_pk_fma_f32 v[172:173], v[72:73], v[36:37], v[172:173] op_sel_hi:[1,0,1]
  v_pk_fma_f32 v[174:175], v[74:75], v[36:37], v[174:175] op_sel_hi:[1,0,1]
  v_pk_fma_f32 v[192:193], v[80:81], v[24:25], v[192:193] op_sel_hi:[1,0,1]
  v_pk_fma_f32 v[194:195], v[82:83], v[24:25], v[194:195] op_sel_hi:[1,0,1]
  v_pk_fma_f32 v[196:197], v[80:81], v[28:29], v[196:197] op_sel_hi:[1,0,1]
  v_pk_fma_f32 v[198:199], v[82:83], v[28:29], v[198:199] op_sel_hi:[1,0,1]
  v_pk_fma_f32 v[200:201], v[80:81], v[32:33], v[200:201] op_sel_hi:[1,0,1]
  v_pk_fma_f32 v[202:203], v[82:83], v[32:33], v[202:203] op_sel_hi:[1,0,1]
  v_pk_fma_f32 v[204:205], v[80:81], v[36:37], v[204:205] op_sel_hi:[1,0,1]
  v_pk_fma_f32 v[206:207], v[82:83], v[36:37], v[206:207] op_sel_hi:[1,0,1]
  v_pk_fma_f32 v[176:177], v[76:77], v[24:25], v[176:177] op_sel_hi:[1,0,1]
  v_pk_fma_f32 v[178:179], v[78:79], v[24:25], v[178:179] op_sel_hi:[1,0,1]
  v_pk_fma_f32 v[180:181], v[76:77], v[28:29], v[180:181] op_sel_hi:[1,0,1]
  v_pk_fma_f32 v[182:183], v[78:79], v[28:29], v[182:183] op_sel_hi:[1,0,1]
  v_pk_fma_f32 v[184:185], v[76:77], v[32:33], v[184:185] op_sel_hi:[1,0,1]
  v_pk_fma_f32 v[186:187], v[78:79], v[32:33], v[186:187] op_sel_hi:[1,0,1]
  v_pk_fma_f32 v[188:189], v[76:77], v[36:37], v[188:189] op_sel_hi:[1,0,1]
  v_pk_fma_f32 v[190:191], v[78:79], v[36:37], v[190:191] op_sel_hi:[1,0,1]
  v_pk_fma_f32 v[208:209], v[84:85], v[24:25], v[208:209] op_sel_hi:[1,0,1]
  v_pk_fma_f32 v[210:211], v[86:87], v[24:25], v[210:211] op_sel_hi:[1,0,1]
  v_pk_fma_f32 v[212:213], v[84:85], v[28:29], v[212:213] op_sel_hi:[1,0,1]
  v_pk_fma_f32 v[214:215], v[86:87], v[28:29], v[214:215] op_sel_hi:[1,0,1]
  v_pk_fma_f32 v[216:217], v[84:85], v[32:33], v[216:217] op_sel_hi:[1,0,1]
  v_pk_fma_f32 v[218:219], v[86:87], v[32:33], v[218:219] op_sel_hi:[1,0,1]
  v_pk_fma_f32 v[220:221], v[84:85], v[36:37], v[220:221] op_sel_hi:[1,0,1]
  v_pk_fma_f32 v[222:223], v[86:87], v[36:37], v[222:223] op_sel_hi:[1,0,1]
  v_pk_mul_f32 v[160:161], v[160:161], v[26:27] op_sel:[0,1] op_sel_hi:[1,1]
  v_pk_mul_f32 v[162:163], v[162:163], v[26:27] op_sel:[0,1] op_sel_hi:[1,1]
  v_pk_mul_f32 v[176:177], v[176:177], v[26:27] op_sel:[0,1] op_sel_hi:[1,1]
  v_pk_mul_f32 v[178:179], v[178:179], v[26:27] op_sel:[0,1] op_sel_hi:[1,1]
  v_pk_mul_f32 v[164:165], v[164:165], v[30:31] op_sel:[0,1] op_sel_hi:[1,1]
  v_pk_mul_f32 v[166:167], v[166:167], v[30:31] op_sel:[0,1] op_sel_hi:[1,1]
  v_pk_mul_f32 v[180:181], v[180:181], v[30:31] op_sel:[0,1] op_sel_hi:[1,1]
  v_pk_mul_f32 v[182:183], v[182:183], v[30:31] op_sel:[0,1] op_sel_hi:[1,1]
  v_pk_mul_f32 v[168:169], v[168:169], v[34:35] op_sel:[0,1] op_sel_hi:[1,1]
  v_pk_mul_f32 v[170:171], v[170:171], v[34:35] op_sel:[0,1] op_sel_hi:[1,1]
  v_pk_mul_f32 v[184:185], v[184:185], v[34:35] op_sel:[0,1] op_sel_hi:[1,1]
  v_pk_mul_f32 v[186:187], v[186:187], v[34:35] op_sel:[0,1] op_sel_hi:[1,1]
  v_pk_mul_f32 v[172:173], v[172:173], v[38:39] op_sel:[0,1] op_sel_hi:[1,1]
  v_pk_mul_f32 v[174:175], v[174:175], v[38:39] op_sel:[0,1] op_sel_hi:[1,1]
  v_pk_mul_f32 v[188:189], v[188:189], v[38:39] op_sel:[0,1] op_sel_hi:[1,1]
  v_pk_mul_f32 v[190:191], v[190:191], v[38:39] op_sel:[0,1] op_sel_hi:[1,1]
  v_exp_f32 v160, v160
  v_exp_f32 v161, v161
  v_exp_f32 v162, v162
  v_exp_f32 v163, v163
  v_exp_f32 v176, v176
  v_exp_f32 v177, v177
  v_exp_f32 v178, v178
  v_exp_f32 v179, v179
  v_exp_f32 v164, v164
  v_exp_f32 v165, v165
  v_exp_f32 v166, v166
  v_exp_f32 v167, v167
  v_exp_f32 v180, v180
  v_exp_f32 v181, v181
  v_exp_f32 v182, v182
  v_exp_f32 v183, v183
  v_exp_f32 v168, v168
  v_exp_f32 v169, v169
  v_exp_f32 v170, v170
  v_exp_f32 v171, v171
  v_exp_f32 v184, v184
  v_exp_f32 v185, v185
  v_exp_f32 v186, v186
  v_exp_f32 v187, v187
  v_exp_f32 v172, v172
  v_exp_f32 v173, v173
  v_exp_f32 v174, v174
  v_exp_f32 v175, v175
  v_exp_f32 v188, v188
  v_exp_f32 v189, v189
  v_exp_f32 v190, v190
  v_exp_f32 v191, v191
  v_pk_fma_f32 v[160:161], v[160:161], v[26:27], v[26:27] op_sel_hi:[1,0,0]
  v_pk_fma_f32 v[162:163], v[162:163], v[26:27], v[26:27] op_sel_hi:[1,0,0]
  v_pk_fma_f32 v[176:177], v[176:177], v[26:27], v[26:27] op_sel_hi:[1,0,0]
  v_pk_fma_f32 v[178:179], v[178:179], v[26:27], v[26:27] op_sel_hi:[1,0,0]
  v_pk_fma_f32 v[164:165], v[164:165], v[30:31], v[30:31] op_sel_hi:[1,0,0]
  v_pk_fma_f32 v[166:167], v[166:167], v[30:31], v[30:31] op_sel_hi:[1,0,0]
  v_pk_fma_f32 v[180:181], v[180:181], v[30:31], v[30:31] op_sel_hi:[1,0,0]
  v_pk_fma_f32 v[182:183], v[182:183], v[30:31], v[30:31] op_sel_hi:[1,0,0]
  v_pk_fma_f32 v[168:169], v[168:169], v[34:35], v[34:35] op_sel_hi:[1,0,0]
  v_pk_fma_f32 v[170:171], v[170:171], v[34:35], v[34:35] op_sel_hi:[1,0,0]
  v_pk_fma_f32 v[184:185], v[184:185], v[34:35], v[34:35] op_sel_hi:[1,0,0]
  v_pk_fma_f32 v[186:187], v[186:187], v[34:35], v[34:35] op_sel_hi:[1,0,0]
  v_pk_fma_f32 v[172:173], v[172:173], v[38:39], v[38:39] op_sel_hi:[1,0,0]
  v_pk_fma_f32 v[174:175], v[174:175], v[38:39], v[38:39] op_sel_hi:[1,0,0]
  v_pk_fma_f32 v[188:189], v[188:189], v[38:39], v[38:39] op_sel_hi:[1,0,0]
  v_pk_fma_f32 v[190:191], v[190:191], v[38:39], v[38:39] op_sel_hi:[1,0,0]
  v_rcp_f32 v160, v160
  v_rcp_f32 v161, v161
  v_rcp_f32 v162, v162
  v_rcp_f32 v163, v163
  v_rcp_f32 v176, v176
  v_rcp_f32 v177, v177
  v_rcp_f32 v178, v178
  v_rcp_f32 v179, v179
  v_rcp_f32 v164, v164
  v_rcp_f32 v165, v165
  v_rcp_f32 v166, v166
  v_rcp_f32 v167, v167
  v_rcp_f32 v180, v180
  v_rcp_f32 v181, v181
  v_rcp_f32 v182, v182
  v_rcp_f32 v183, v183
  v_rcp_f32 v168, v168
  v_rcp_f32 v169, v169
  v_rcp_f32 v170, v170
  v_rcp_f32 v171, v171
  v_rcp_f32 v184, v184
  v_rcp_f32 v185, v185
  v_rcp_f32 v186, v186
  v_rcp_f32 v187, v187
  v_rcp_f32 v172, v172
  v_rcp_f32 v173, v173
  v_rcp_f32 v174, v174
  v_rcp_f32 v175, v175
  v_rcp_f32 v188, v188
  v_rcp_f32 v189, v189
  v_rcp_f32 v190, v190
  v_rcp_f32 v191, v191
  v_pk_mul_f32 v[160:161], v[160:161], v[192:193]
  v_pk_mul_f32 v[162:163], v[162:163], v[194:195]
  v_pk_mul_f32 v[176:177], v[176:177], v[208:209]
  v_pk_mul_f32 v[178:179], v[178:179], v[210:211]
  v_pk_mul_f32 v[164:165], v[164:165], v[196:197]
  v_pk_mul_f32 v[166:167], v[166:167], v[198:199]
  v_pk_mul_f32 v[180:181], v[180:181], v[212:213]
  v_pk_mul_f32 v[182:183], v[182:183], v[214:215]
  v_pk_mul_f32 v[168:169], v[168:169], v[200:201]
  v_pk_mul_f32 v[170:171], v[170:171], v[202:203]
  v_pk_mul_f32 v[184:185], v[184:185], v[216:217]
  v_pk_mul_f32 v[186:187], v[186:187], v[218:219]
  v_pk_mul_f32 v[172:173], v[172:173], v[204:205]
  v_pk_mul_f32 v[174:175], v[174:175], v[206:207]
  v_pk_mul_f32 v[188:189], v[188:189], v[220:221]
  v_pk_mul_f32 v[190:191], v[190:191], v[222:223]
  v_cvt_pk_bf16_f32 v160, v160, v161
  v_cvt_pk_bf16_f32 v161, v162, v163
  v_cvt_pk_bf16_f32 v162, v176, v177
  v_cvt_pk_bf16_f32 v163, v178, v179
  v_cvt_pk_bf16_f32 v164, v164, v165
  v_cvt_pk_bf16_f32 v165, v166, v167
  v_cvt_pk_bf16_f32 v166, v180, v181
  v_cvt_pk_bf16_f32 v167, v182, v183
  v_cvt_pk_bf16_f32 v168, v168, v169
  v_cvt_pk_bf16_f32 v169, v170, v171
  v_cvt_pk_bf16_f32 v170, v184, v185
  v_cvt_pk_bf16_f32 v171, v186, v187
  v_cvt_pk_bf16_f32 v172, v172, v173
  v_cvt_pk_bf16_f32 v173, v174, v175
  v_cvt_pk_bf16_f32 v174, v188, v189
  v_cvt_pk_bf16_f32 v175, v190, v191
  s_waitcnt lgkmcnt(0)
  s_waitcnt vmcnt(0)
  v_mov_b32 v18, 1
  s_mov_b64 exec, 1
  ds_add_rtn_u32 v18, v19, v18
  s_mov_b64 exec, -1
  s_waitcnt lgkmcnt(0)
  v_readfirstlane_b32 s48, v18
  s_cmp_lg_u32 s48, 3
  s_cbranch_scc1 L_fa_31
  s_mov_b64 exec, 1
  buffer_store_dword v23, v17, s[28:31], s67 offen sc1
  s_mov_b64 exec, -1
L_fa_31:
  v_permlane16_swap_b32 v160, v162
  v_permlane16_swap_b32 v161, v163
  buffer_store_dwordx4 v[160:163], v16, s[28:31], s65 offen offset:0 sc1
  v_permlane16_swap_b32 v164, v166
  v_permlane16_swap_b32 v165, v167
  buffer_store_dwordx4 v[164:167], v16, s[28:31], s65 offen offset:256 sc1
  v_permlane16_swap_b32 v168, v170
  v_permlane16_swap_b32 v169, v171
  buffer_store_dwordx4 v[168:171], v16, s[28:31], s65 offen offset:512 sc1
  v_permlane16_swap_b32 v172, v174
  v_permlane16_swap_b32 v173, v175
  buffer_store_dwordx4 v[172:175], v16, s[28:31], s65 offen offset:768 sc1
L_epi_done:
  s_mov_b32 s42, s68
  v_mov_b32 v18, 1
  v_mov_b32 v22, 155160
  s_mov_b64 exec, 1
  ds_add_u32 v22, v18
  s_mov_b64 exec, -1
  s_lshl_b32 s32, s26, 2
  s_and_b32 s48, s27, 3
  s_add_u32 s32, s32, s48
  s_lshr_b32 s33, s27, 2
  s_and_b32 s34, s32, 1
  v_and_b32 v56, 31, v0
  v_lshrrev_b32 v57, 5, v0
  s_lshl_b32 s35, s3, 6
  v_add_u32 v58, s35, v56
  v_lshlrev_b32 v58, 4, v58
  v_add_u32 v59, s34, v57
  v_lshl_add_u32 v2, v59, 13, v58
  v_lshlrev_b32 v5, 4, v56
  v_lshl_add_u32 v5, v59, 10, v5
  s_xor_b32 s48, s34, 1
  s_lshl_b32 s49, s48, 14
  s_lshl_b32 s48, s48, 11
  v_add_u32 v3, s49, v58
  v_lshlrev_b32 v6, 4, v56
  v_add_u32 v6, s48, v6
  v_lshlrev_b32 v9, 4, v56
  v_lshl_add_u32 v9, v57, 10, v9
  v_lshlrev_b32 v10, 3, v56
  v_bfe_u32 v59, v0, 4, 1
  v_and_b32 v60, 3, v0
  v_lshl_add_u32 v59, v59, 2, v60
  v_min_u32 v59, 5, v59
  v_add_u32 v59, s34, v59
  v_cmp_eq_u32 vcc, 6, v59
  s_nop 1
  v_cndmask_b32 v59, v59, 0, vcc
  v_lshrrev_b32 v60, 1, v59
  v_mul_u32_u24 v60, 8256, v60
  v_and_b32 v59, 1, v59
  v_lshl_add_u32 v60, v59, 3, v60
  v_bfe_u32 v59, v0, 2, 2
  v_lshl_add_u32 v59, v57, 2, v59
  v_add_u32 v59, s35, v59
  v_lshl_add_u32 v4, v59, 4, v60
  v_add_u32 v4, 24576, v4
  v_cmp_eq_u32 vcc, 0, v57
  s_sub_u32 s48, s34, 1
  s_sub_u32 s49, 0, s34
  v_mov_b32 v59, s48
  v_mov_b32 v60, s49
  v_cndmask_b32 v7, 0, v59, vcc
  v_cndmask_b32 v8, 0, v60, vcc
  v_and_b32 v16, 0x3f80, v7
  v_and_b32 v11, 0x3f80, v8
  v_mov_b32 v59, 0x3f803f80
  v_cndmask_b32 v36, 0, v59, vcc
  v_mov_b32 v60, 1073741824
  v_cndmask_b32 v10, v60, v10, vcc
  v_mov_b32 v37, 0
  v_mov_b32 v38, 0
  v_mov_b32 v39, 0
  v_mov_b32 v33, 0
  v_mov_b32 v34, 0
  v_mov_b32 v35, 0
  v_lshlrev_b32 v59, 2, v57
  v_sub_u32 v59, v56, v59
  v_cmp_le_i32 s[52:53], 0, v59
  v_cmp_le_i32 s[54:55], 1, v59
  v_cmp_le_i32 s[56:57], 2, v59
  v_cmp_le_i32 s[58:59], 3, v59
  v_cmp_le_i32 s[60:61], 8, v59
  v_cmp_le_i32 s[62:63], 9, v59
  v_cmp_le_i32 s[64:65], 10, v59
  v_cmp_le_i32 s[66:67], 11, v59
  v_cmp_le_i32 s[68:69], 16, v59
  v_cmp_le_i32 s[70:71], 17, v59
  v_cmp_le_i32 s[72:73], 18, v59
  v_cmp_le_i32 s[74:75], 19, v59
  v_cmp_le_i32 s[76:77], 24, v59
  v_cmp_le_i32 s[78:79], 25, v59
  v_cmp_le_i32 s[80:81], 26, v59
  v_cmp_le_i32 s[82:83], 27, v59
  v_mov_b32 v60, 0xffff
  v_mov_b32 v61, 0xffff0000
  v_cndmask_b32 v62, 0, v60, s[52:53]
  v_cndmask_b32 v63, 0, v61, s[54:55]
  v_or_b32 v24, v62, v63
  v_cndmask_b32 v62, 0, v60, s[56:57]
  v_cndmask_b32 v63, 0, v61, s[58:59]
  v_or_b32 v25, v62, v63
  v_cndmask_b32 v62, 0, v60, s[60:61]
  v_cndmask_b32 v63, 0, v61, s[62:63]
  v_or_b32 v26, v62, v63
  v_cndmask_b32 v62, 0, v60, s[64:65]
  v_cndmask_b32 v63, 0, v61, s[66:67]
  v_or_b32 v27, v62, v63
  v_cndmask_b32 v62, 0, v60, s[68:69]
  v_cndmask_b32 v63, 0, v61, s[70:71]
  v_or_b32 v28, v62, v63
  v_cndmask_b32 v62, 0, v60, s[72:73]
  v_cndmask_b32 v63, 0, v61, s[74:75]
  v_or_b32 v29, v62, v63
  v_cndmask_b32 v62, 0, v60, s[76:77]
  v_cndmask_b32 v63, 0, v61, s[78:79]
  v_or_b32 v30, v62, v63
  v_cndmask_b32 v62, 0, v60, s[80:81]
  v_cndmask_b32 v63, 0, v61, s[82:83]
  v_or_b32 v31, v62, v63
  s_lshl_b32 s36, s33, 2
  s_add_u32 s36, s36, s3
  s_lshl_b32 s37, s36, 16
  s_lshl_b32 s48, s32, 11
  s_add_u32 s37, s37, s48
  s_add_u32 s37, s37, 14155776
  s_lshl_b32 s38, s36, 14
  s_lshl_b32 s48, s32, 9
  s_add_u32 s38, s38, s48
  s_add_u32 s38, s38, 16252928
  s_lshl_b32 s39, s36, 5
  s_add_u32 s39, s39, s32
  s_lshl_b32 s39, s39, 2
  s_add_u32 s39, s39, 19685376
  s_mul_i32 s40, s32, 5
  s_lshr_b32 s40, s40, 1
  s_lshl_b32 s40, s40, 10
  s_mul_i32 s43, s36, 245760
  s_add_u32 s43, s43, s40
  s_waitcnt vmcnt(0)
  v_mov_b32 v18, 1
  s_mov_b64 exec, 1
  ds_add_rtn_u32 v18, v21, v18
  s_mov_b64 exec, -1
  s_waitcnt lgkmcnt(0)
  v_readfirstlane_b32 s48, v18
  s_cmp_lg_u32 s48, 3
  s_cbranch_scc1 L_fa_32
  s_mov_b64 exec, 1
  buffer_store_dword v23, v17, s[28:31], s42 offen sc1
  s_mov_b64 exec, -1
L_fa_32:
  v_mov_b32 v60, 155152
  s_mov_b32 s48, 0
L_mq_w_33:
  ds_read_b32 v61, v60
  s_waitcnt lgkmcnt(0)
  v_readfirstlane_b32 s49, v61
  s_cmp_ge_u32 s49, 1
  s_cbranch_scc1 L_mq_g_34
  s_add_u32 s48, s48, 1
  s_cmp_ge_u32 s48, 1200000
  s_cbranch_scc1 L_mq_g_34
  s_sleep 2
  s_branch L_mq_w_33
L_mq_g_34:
  buffer_load_dwordx4 v[48:51], v5, s[28:31], s43 offen offset:0 sc1
  buffer_load_dwordx4 v[52:55], v6, s[28:31], s43 offen offset:0 sc1
  buffer_load_dwordx4 v[40:43], v5, s[28:31], s43 offen offset:512 sc1
  buffer_load_dwordx4 v[44:47], v6, s[28:31], s43 offen offset:512 sc1
  s_waitcnt vmcnt(0)
  v_mov_b32 v60, 155140
  s_mov_b32 s48, 0
L_akv_w_35:
  ds_read_b32 v61, v60
  s_waitcnt lgkmcnt(0)
  v_readfirstlane_b32 s49, v61
  s_cmp_ge_u32 s49, 4
  s_cbranch_scc1 L_akv_g_36
  s_add_u32 s48, s48, 1
  s_cmp_ge_u32 s48, 1200000
  s_cbranch_scc1 L_akv_g_36
  s_sleep 0
  s_branch L_akv_w_35
L_akv_g_36:
  s_setprio 3
  ds_read_b128 v[80:83], v2 offset:4096
  ds_read_b128 v[84:87], v3 offset:4096
  ds_read_b128 v[88:91], v2 offset:0
  ds_read_b128 v[92:95], v3 offset:0
  ds_read_b64_tr_b16 v[56:57], v4 offset:4096
  ds_read_b64_tr_b16 v[58:59], v4 offset:4224
  ds_read_b64_tr_b16 v[60:61], v4 offset:4352
  ds_read_b64_tr_b16 v[62:63], v4 offset:4480
  ds_read_b64_tr_b16 v[64:65], v4 offset:0
  ds_read_b64_tr_b16 v[66:67], v4 offset:128
  ds_read_b64_tr_b16 v[68:69], v4 offset:256
  ds_read_b64_tr_b16 v[70:71], v4 offset:384
  ds_read_b64_tr_b16 v[72:73], v4 offset:512
  ds_read_b64_tr_b16 v[74:75], v4 offset:640
  ds_read_b64_tr_b16 v[76:77], v4 offset:768
  ds_read_b64_tr_b16 v[78:79], v4 offset:896
  v_and_or_b32 v52, v52, v7, v11
  v_and_b32 v53, v53, v7
  v_and_or_b32 v54, v54, v8, v16
  v_and_b32 v55, v55, v8
  v_and_or_b32 v44, v44, v7, v11
  v_and_b32 v45, v45, v7
  v_and_or_b32 v46, v46, v8, v16
  v_and_b32 v47, v47, v8
  s_waitcnt lgkmcnt(15)
  v_mfma_f32_32x32x16_bf16 v[240:255], v[80:83], v[48:51], 0
  ds_read_b128 v[80:83], v2 offset:512
  s_waitcnt lgkmcnt(15)
  v_mfma_f32_32x32x16_bf16 v[240:255], v[84:87], v[52:55], v[240:255]
  ds_read_b128 v[84:87], v3 offset:512
  s_waitcnt lgkmcnt(15)
  v_mfma_f32_32x32x16_bf16 v[112:127], v[88:91], v[48:51], 0
  ds_read_b128 v[88:91], v2 offset:1024
  s_waitcnt lgkmcnt(15)
  v_mfma_f32_32x32x16_bf16 v[112:127], v[92:95], v[52:55], v[112:127]
  ds_read_b128 v[92:95], v3 offset:1024
  s_waitcnt lgkmcnt(3)
  v_mfma_f32_32x32x16_bf16 v[128:143], v[80:83], v[48:51], 0
  ds_read_b128 v[80:83], v2 offset:1536
  s_waitcnt lgkmcnt(3)
  v_mfma_f32_32x32x16_bf16 v[128:143], v[84:87], v[52:55], v[128:143]
  ds_read_b128 v[84:87], v3 offset:1536
  s_nop 4
  v_cndmask_b32 v240, v112, v240, s[52:53]
  v_cndmask_b32 v241, v113, v241, s[54:55]
  v_cndmask_b32 v242, v114, v242, s[56:57]
  v_cndmask_b32 v243, v115, v243, s[58:59]
  v_cndmask_b32 v244, v116, v244, s[60:61]
  s_waitcnt lgkmcnt(3)
  v_mfma_f32_32x32x16_bf16 v[144:159], v[88:91], v[48:51], 0
  ds_read_b128 v[88:91], v2 offset:2048
  v_cndmask_b32 v245, v117, v245, s[62:63]
  v_cndmask_b32 v246, v118, v246, s[64:65]
  v_cndmask_b32 v247, v119, v247, s[66:67]
  v_cndmask_b32 v248, v120, v248, s[68:69]
  v_cndmask_b32 v249, v121, v249, s[70:71]
  s_waitcnt lgkmcnt(3)
  v_mfma_f32_32x32x16_bf16 v[144:159], v[92:95], v[52:55], v[144:159]
  ds_read_b128 v[92:95], v3 offset:2048
  v_cndmask_b32 v250, v122, v250, s[72:73]
  v_cndmask_b32 v251, v123, v251, s[74:75]
  v_cndmask_b32 v252, v124, v252, s[76:77]
  v_cndmask_b32 v253, v125, v253, s[78:79]
  v_max_f32 v12, v240, v241
  s_waitcnt lgkmcnt(3)
  v_mfma_f32_32x32x16_bf16 v[160:175], v[80:83], v[48:51], 0
  ds_read_b128 v[80:83], v2 offset:2560
  v_max_f32 v13, v242, v243
  v_max_f32 v14, v244, v245
  v_cndmask_b32 v254, v126, v254, s[80:81]
  v_cndmask_b32 v255, v127, v255, s[82:83]
  v_max_f32 v15, v246, v247
  s_waitcnt lgkmcnt(3)
  v_mfma_f32_32x32x16_bf16 v[160:175], v[84:87], v[52:55], v[160:175]
  ds_read_b128 v[84:87], v3 offset:2560
  v_max3_f32 v12, v12, v248, v249
  v_max3_f32 v13, v13, v250, v251
  v_max3_f32 v14, v14, v252, v253
  v_max3_f32 v15, v15, v254, v255
  v_max3_f32 v12, v12, v128, v129
  s_waitcnt lgkmcnt(3)
  v_mfma_f32_32x32x16_bf16 v[176:191], v[88:91], v[48:51], 0
  ds_read_b128 v[88:91], v2 offset:3072
  v_max3_f32 v13, v13, v130, v131
  v_max3_f32 v14, v14, v132, v133
  v_max3_f32 v15, v15, v134, v135
  v_max3_f32 v12, v12, v136, v137
  v_max3_f32 v13, v13, v138, v139
  s_waitcnt lgkmcnt(3)
  v_mfma_f32_32x32x16_bf16 v[176:191], v[92:95], v[52:55], v[176:191]
  ds_read_b128 v[92:95], v3 offset:3072
  v_max3_f32 v14, v14, v140, v141
  v_max3_f32 v15, v15, v142, v143
  v_max3_f32 v12, v12, v144, v145
  v_max3_f32 v13, v13, v146, v147
  v_max3_f32 v14, v14, v148, v149
  s_waitcnt lgkmcnt(3)
  v_mfma_f32_32x32x16_bf16 v[192:207], v[80:83], v[48:51], 0
  ds_read_b128 v[80:83], v2 offset:3584
  v_max3_f32 v15, v15, v150, v151
  v_max3_f32 v12, v12, v152, v153
  v_max3_f32 v13, v13, v154, v155
  v_max3_f32 v14, v14, v156, v157
  v_max3_f32 v15, v15, v158, v159
  s_waitcnt lgkmcnt(3)
  v_mfma_f32_32x32x16_bf16 v[192:207], v[84:87], v[52:55], v[192:207]
  ds_read_b128 v[84:87], v3 offset:3584
  v_max3_f32 v12, v12, v160, v161
  v_max3_f32 v13, v13, v162, v163
  v_max3_f32 v14, v14, v164, v165
  v_max3_f32 v15, v15, v166, v167
  v_max3_f32 v12, v12, v168, v169
  s_waitcnt lgkmcnt(3)
  v_mfma_f32_32x32x16_bf16 v[208:223], v[88:91], v[48:51], 0
  ds_read_b128 v[88:91], v2 offset:4608
  v_max3_f32 v13, v13, v170, v171
  v_max3_f32 v14, v14, v172, v173
  v_max3_f32 v15, v15, v174, v175
  v_max3_f32 v12, v12, v176, v177
  v_max3_f32 v13, v13, v178, v179
  s_waitcnt lgkmcnt(3)
  v_mfma_f32_32x32x16_bf16 v[208:223], v[92:95], v[52:55], v[208:223]
  ds_read_b128 v[92:95], v3 offset:4608
  v_max3_f32 v14, v14, v180, v181
  v_max3_f32 v15, v15, v182, v183
  v_max3_f32 v12, v12, v184, v185
  v_max3_f32 v13, v13, v186, v187
  v_max3_f32 v14, v14, v188, v189
  s_waitcnt lgkmcnt(3)
  v_mfma_f32_32x32x16_bf16 v[224:239], v[80:83], v[48:51], 0
  ds_read_b128 v[80:83], v2 offset:512
  v_max3_f32 v15, v15, v190, v191
  v_max3_f32 v12, v12, v192, v193
  v_max3_f32 v13, v13, v194, v195
  v_max3_f32 v14, v14, v196, v197
  v_max3_f32 v15, v15, v198, v199
  s_waitcnt lgkmcnt(3)
  v_mfma_f32_32x32x16_bf16 v[224:239], v[84:87], v[52:55], v[224:239]
  ds_read_b128 v[84:87], v3 offset:512
  v_max3_f32 v12, v12, v200, v201
  v_max3_f32 v13, v13, v202, v203
  v_max3_f32 v14, v14, v204, v205
  v_max3_f32 v15, v15, v206, v207
  v_max3_f32 v12, v12, v208, v209
  s_waitcnt lgkmcnt(3)
  v_mfma_f32_32x32x16_bf16 v[112:127], v[88:91], v[40:43], 0
  ds_read_b128 v[88:91], v2 offset:1024
  v_max3_f32 v13, v13, v210, v211
  v_max3_f32 v14, v14, v212, v213
  v_max3_f32 v15, v15, v214, v215
  v_max3_f32 v12, v12, v216, v217
  v_max3_f32 v13, v13, v218, v219
  s_waitcnt lgkmcnt(3)
  v_mfma_f32_32x32x16_bf16 v[112:127], v[92:95], v[44:47], v[112:127]
  ds_read_b128 v[92:95], v3 offset:1024
  v_max3_f32 v14, v14, v220, v221
  v_max3_f32 v15, v15, v222, v223
  v_max3_f32 v12, v12, v224, v225
  v_max3_f32 v13, v13, v226, v227
  v_max3_f32 v14, v14, v228, v229
  v_max3_f32 v15, v15, v230, v231
  v_max3_f32 v12, v12, v232, v233
  v_max3_f32 v13, v13, v234, v235
  v_max3_f32 v14, v14, v236, v237
  v_max3_f32 v15, v15, v238, v239
  v_max3_f32 v12, v12, v13, v14
  v_max_f32 v12, v12, v15
  v_mov_b32 v13, v12
  s_nop 1
  v_permlane32_swap_b32 v12, v13
  v_max_f32 v12, v12, v13
  v_xor_b32 v12, 0x80000000, v12
  v_and_b32 v13, 0xffff0000, v12
  v_sub_f32 v12, v12, v13
  v_cvt_pk_bf16_f32 v32, v13, v12
  s_nop 1
  v_mfma_f32_32x32x16_bf16 v[240:255], v[36:39], v[32:35], v[240:255]
  v_mfma_f32_32x32x16_bf16 v[128:143], v[36:39], v[32:35], v[128:143]
  v_mfma_f32_32x32x16_bf16 v[144:159], v[36:39], v[32:35], v[144:159]
  s_nop 9
  v_exp_f32 v240, v240
  v_exp_f32 v241, v241
  v_exp_f32 v242, v242
  v_mfma_f32_32x32x16_bf16 v[160:175], v[36:39], v[32:35], v[160:175]
  v_exp_f32 v243, v243
  v_exp_f32 v244, v244
  v_exp_f32 v245, v245
  v_mfma_f32_32x32x16_bf16 v[176:191], v[36:39], v[32:35], v[176:191]
  v_exp_f32 v246, v246
  v_exp_f32 v247, v247
  v_exp_f32 v248, v248
  v_mfma_f32_32x32x16_bf16 v[192:207], v[36:39], v[32:35], v[192:207]
  v_exp_f32 v249, v249
  v_exp_f32 v250, v250
  v_exp_f32 v251, v251
  v_mfma_f32_32x32x16_bf16 v[208:223], v[36:39], v[32:35], v[208:223]
  v_cvt_pk_bf16_f32 v240, v240, v241
  v_cvt_pk_bf16_f32 v241, v242, v243
  v_cvt_pk_bf16_f32 v242, v244, v245
  v_cvt_pk_bf16_f32 v243, v246, v247
  v_cvt_pk_bf16_f32 v244, v248, v249
  v_cvt_pk_bf16_f32 v245, v250, v251
  v_mfma_f32_32x32x16_bf16 v[224:239], v[36:39], v[32:35], v[224:239]
  v_and_b32 v248, v240, v24
  v_and_b32 v249, v241, v25
  v_and_b32 v250, v242, v26
  v_and_b32 v251, v243, v27
  v_exp_f32 v252, v252
  s_nop 0
  v_mfma_f32_32x32x16_bf16 v[96:111], v[56:59], v[248:251], 0
  ds_read_b64_tr_b16 v[56:57], v4 offset:1024
  ds_read_b64_tr_b16 v[58:59], v4 offset:1152
  v_exp_f32 v253, v253
  v_exp_f32 v254, v254
  v_exp_f32 v255, v255
  v_cvt_pk_bf16_f32 v246, v252, v253
  v_cvt_pk_bf16_f32 v247, v254, v255
  v_and_b32 v252, v244, v28
  v_and_b32 v253, v245, v29
  v_and_b32 v254, v246, v30
  v_and_b32 v255, v247, v31
  v_xor_b32 v240, v240, v248
  v_xor_b32 v241, v241, v249
  v_mfma_f32_32x32x16_bf16 v[96:111], v[60:63], v[252:255], v[96:111]
  ds_read_b64_tr_b16 v[60:61], v4 offset:1280
  ds_read_b64_tr_b16 v[62:63], v4 offset:1408
  v_xor_b32 v242, v242, v250
  v_xor_b32 v243, v243, v251
  v_xor_b32 v244, v244, v252
  v_xor_b32 v245, v245, v253
  v_mfma_f32_32x32x16_bf16 v[96:111], v[64:67], v[240:243], v[96:111]
  ds_read_b64_tr_b16 v[64:65], v4 offset:1536
  ds_read_b64_tr_b16 v[66:67], v4 offset:1664
  v_xor_b32 v246, v246, v254
  v_xor_b32 v247, v247, v255
  v_exp_f32 v128, v128
  s_nop 0
  v_mfma_f32_32x32x16_bf16 v[96:111], v[68:71], v[244:247], v[96:111]
  ds_read_b64_tr_b16 v[68:69], v4 offset:1792
  ds_read_b64_tr_b16 v[70:71], v4 offset:1920
  v_exp_f32 v129, v129
  v_exp_f32 v130, v130
  s_waitcnt lgkmcnt(11)
  v_mfma_f32_32x32x16_bf16 v[240:255], v[80:83], v[40:43], 0
  ds_read_b128 v[80:83], v2 offset:1536
  v_exp_f32 v131, v131
  v_exp_f32 v132, v132
  v_exp_f32 v133, v133
  s_waitcnt lgkmcnt(11)
  v_mfma_f32_32x32x16_bf16 v[240:255], v[84:87], v[44:47], v[240:255]
  ds_read_b128 v[84:87], v3 offset:1536
  v_exp_f32 v134, v134
  v_exp_f32 v135, v135
  v_cvt_pk_bf16_f32 v128, v128, v129
  v_cvt_pk_bf16_f32 v129, v130, v131
  v_cvt_pk_bf16_f32 v130, v132, v133
  v_cvt_pk_bf16_f32 v131, v134, v135
  v_exp_f32 v136, v136
  s_nop 0
  v_mfma_f32_32x32x16_bf16 v[96:111], v[72:75], v[128:131], v[96:111]
  ds_read_b64_tr_b16 v[72:73], v4 offset:2048
  ds_read_b64_tr_b16 v[74:75], v4 offset:2176
  v_exp_f32 v137, v137
  v_exp_f32 v138, v138
  v_exp_f32 v139, v139
  v_exp_f32 v140, v140
  v_exp_f32 v141, v141
  v_exp_f32 v142, v142
  v_exp_f32 v143, v143
  v_cvt_pk_bf16_f32 v132, v136, v137
  v_cvt_pk_bf16_f32 v133, v138, v139
  v_cvt_pk_bf16_f32 v134, v140, v141
  v_cvt_pk_bf16_f32 v135, v142, v143
  v_exp_f32 v144, v144
  s_nop 0
  v_mfma_f32_32x32x16_bf16 v[96:111], v[76:79], v[132:135], v[96:111]
  ds_read_b64_tr_b16 v[76:77], v4 offset:2304
  ds_read_b64_tr_b16 v[78:79], v4 offset:2432
  v_exp_f32 v145, v145
  v_exp_f32 v146, v146
  s_waitcnt lgkmcnt(15)
  v_mfma_f32_32x32x16_bf16 v[128:143], v[88:91], v[40:43], 0
  ds_read_b128 v[88:91], v2 offset:2048
  v_exp_f32 v147, v147
  v_exp_f32 v148, v148
  v_exp_f32 v149, v149
  s_waitcnt lgkmcnt(15)
  v_mfma_f32_32x32x16_bf16 v[128:143], v[92:95], v[44:47], v[128:143]
  ds_read_b128 v[92:95], v3 offset:2048
  v_exp_f32 v150, v150
  v_exp_f32 v151, v151
  v_cvt_pk_bf16_f32 v144, v144, v145
  v_cvt_pk_bf16_f32 v145, v146, v147
  v_cvt_pk_bf16_f32 v146, v148, v149
  v_cvt_pk_bf16_f32 v147, v150, v151
  v_exp_f32 v152, v152
  s_waitcnt lgkmcnt(14)
  v_mfma_f32_32x32x16_bf16 v[96:111], v[56:59], v[144:147], v[96:111]
  ds_read_b64_tr_b16 v[56:57], v4 offset:2560
  ds_read_b64_tr_b16 v[58:59], v4 offset:2688
  v_exp_f32 v153, v153
  v_exp_f32 v154, v154
  v_exp_f32 v155, v155
  v_exp_f32 v156, v156
  v_exp_f32 v157, v157
  v_exp_f32 v158, v158
  v_exp_f32 v159, v159
  v_cvt_pk_bf16_f32 v148, v152, v153
  v_cvt_pk_bf16_f32 v149, v154, v155
  v_cvt_pk_bf16_f32 v150, v156, v157
  v_cvt_pk_bf16_f32 v151, v158, v159
  v_exp_f32 v160, v160
  s_waitcnt lgkmcnt(14)
  v_mfma_f32_32x32x16_bf16 v[96:111], v[60:63], v[148:151], v[96:111]
  ds_read_b64_tr_b16 v[60:61], v4 offset:2816
  ds_read_b64_tr_b16 v[62:63], v4 offset:2944
  v_exp_f32 v161, v161
  v_exp_f32 v162, v162
  s_waitcnt lgkmcnt(11)
  v_mfma_f32_32x32x16_bf16 v[144:159], v[80:83], v[40:43], 0
  ds_read_b128 v[80:83], v2 offset:2560
  v_exp_f32 v163, v163
  v_exp_f32 v164, v164
  v_exp_f32 v165, v165
  s_waitcnt lgkmcnt(11)
  v_mfma_f32_32x32x16_bf16 v[144:159], v[84:87], v[44:47], v[144:159]
  ds_read_b128 v[84:87], v3 offset:2560
  v_exp_f32 v166, v166
  v_exp_f32 v167, v167
  v_cvt_pk_bf16_f32 v160, v160, v161
  v_cvt_pk_bf16_f32 v161, v162, v163
  v_cvt_pk_bf16_f32 v162, v164, v165
  v_cvt_pk_bf16_f32 v163, v166, v167
  v_exp_f32 v168, v168
  s_nop 0
  v_mfma_f32_32x32x16_bf16 v[96:111], v[64:67], v[160:163], v[96:111]
  ds_read_b64_tr_b16 v[64:65], v4 offset:3072
  ds_read_b64_tr_b16 v[66:67], v4 offset:3200
  v_exp_f32 v169, v169
  v_exp_f32 v170, v170
  v_exp_f32 v171, v171
  v_exp_f32 v172, v172
  v_exp_f32 v173, v173
  v_exp_f32 v174, v174
  v_exp_f32 v175, v175
  v_cvt_pk_bf16_f32 v164, v168, v169
  v_cvt_pk_bf16_f32 v165, v170, v171
  v_cvt_pk_bf16_f32 v166, v172, v173
  v_cvt_pk_bf16_f32 v167, v174, v175
  v_exp_f32 v176, v176
  s_nop 0
  v_mfma_f32_32x32x16_bf16 v[96:111], v[68:71], v[164:167], v[96:111]
  ds_read_b64_tr_b16 v[68:69], v4 offset:3328
  ds_read_b64_tr_b16 v[70:71], v4 offset:3456
  v_exp_f32 v177, v177
  v_exp_f32 v178, v178
  s_waitcnt lgkmcnt(11)
  v_mfma_f32_32x32x16_bf16 v[160:175], v[88:91], v[40:43], 0
  ds_read_b128 v[88:91], v2 offset:3072
  v_exp_f32 v179, v179
  v_exp_f32 v180, v180
  v_exp_f32 v181, v181
  s_waitcnt lgkmcnt(11)
  v_mfma_f32_32x32x16_bf16 v[160:175], v[92:95], v[44:47], v[160:175]
  ds_read_b128 v[92:95], v3 offset:3072
  v_exp_f32 v182, v182
  v_exp_f32 v183, v183
  v_cvt_pk_bf16_f32 v176, v176, v177
  v_cvt_pk_bf16_f32 v177, v178, v179
  v_cvt_pk_bf16_f32 v178, v180, v181
  v_cvt_pk_bf16_f32 v179, v182, v183
  v_exp_f32 v184, v184
  s_nop 0
  v_mfma_f32_32x32x16_bf16 v[96:111], v[72:75], v[176:179], v[96:111]
  ds_read_b64_tr_b16 v[72:73], v4 offset:3584
  ds_read_b64_tr_b16 v[74:75], v4 offset:3712
  v_exp_f32 v185, v185
  v_exp_f32 v186, v186
  v_exp_f32 v187, v187
  v_exp_f32 v188, v188
  v_exp_f32 v189, v189
  v_exp_f32 v190, v190
  v_exp_f32 v191, v191
  v_cvt_pk_bf16_f32 v180, v184, v185
  v_cvt_pk_bf16_f32 v181, v186, v187
  v_cvt_pk_bf16_f32 v182, v188, v189
  v_cvt_pk_bf16_f32 v183, v190, v191
  v_exp_f32 v192, v192
  s_nop 0
  v_mfma_f32_32x32x16_bf16 v[96:111], v[76:79], v[180:183], v[96:111]
  ds_read_b64_tr_b16 v[76:77], v4 offset:3840
  ds_read_b64_tr_b16 v[78:79], v4 offset:3968
  v_exp_f32 v193, v193
  v_exp_f32 v194, v194
  s_waitcnt lgkmcnt(11)
  v_mfma_f32_32x32x16_bf16 v[176:191], v[80:83], v[40:43], 0
  ds_read_b128 v[80:83], v2 offset:3584
  v_exp_f32 v195, v195
  v_exp_f32 v196, v196
  v_exp_f32 v197, v197
  s_waitcnt lgkmcnt(11)
  v_mfma_f32_32x32x16_bf16 v[176:191], v[84:87], v[44:47], v[176:191]
  ds_read_b128 v[84:87], v3 offset:3584
  v_exp_f32 v198, v198
  v_exp_f32 v199, v199
  v_cvt_pk_bf16_f32 v192, v192, v193
  v_cvt_pk_bf16_f32 v193, v194, v195
  v_cvt_pk_bf16_f32 v194, v196, v197
  v_cvt_pk_bf16_f32 v195, v198, v199
  v_exp_f32 v200, v200
  s_nop 0
  v_mfma_f32_32x32x16_bf16 v[96:111], v[56:59], v[192:195], v[96:111]
  ds_read_b64_tr_b16 v[56:57], v4 offset:4608
  ds_read_b64_tr_b16 v[58:59], v4 offset:4736
  v_exp_f32 v201, v201
  v_exp_f32 v202, v202
  v_exp_f32 v203, v203
  v_exp_f32 v204, v204
  v_exp_f32 v205, v205
  v_exp_f32 v206, v206
  v_exp_f32 v207, v207
  v_cvt_pk_bf16_f32 v196, v200, v201
  v_cvt_pk_bf16_f32 v197, v202, v203
  v_cvt_pk_bf16_f32 v198, v204, v205
  v_cvt_pk_bf16_f32 v199, v206, v207
  v_exp_f32 v208, v208
  s_nop 0
  v_mfma_f32_32x32x16_bf16 v[96:111], v[60:63], v[196:199], v[96:111]
  ds_read_b64_tr_b16 v[60:61], v4 offset:4864
  ds_read_b64_tr_b16 v[62:63], v4 offset:4992
  v_exp_f32 v209, v209
  v_exp_f32 v210, v210
  s_waitcnt lgkmcnt(11)
  v_mfma_f32_32x32x16_bf16 v[192:207], v[88:91], v[40:43], 0
  ds_read_b128 v[88:91], v2 offset:4096
  v_exp_f32 v211, v211
  v_exp_f32 v212, v212
  v_exp_f32 v213, v213
  s_waitcnt lgkmcnt(11)
  v_mfma_f32_32x32x16_bf16 v[192:207], v[92:95], v[44:47], v[192:207]
  ds_read_b128 v[92:95], v3 offset:4096
  v_exp_f32 v214, v214
  v_exp_f32 v215, v215
  v_cvt_pk_bf16_f32 v208, v208, v209
  v_cvt_pk_bf16_f32 v209, v210, v211
  v_cvt_pk_bf16_f32 v210, v212, v213
  v_cvt_pk_bf16_f32 v211, v214, v215
  v_exp_f32 v216, v216
  s_nop 0
  v_mfma_f32_32x32x16_bf16 v[96:111], v[64:67], v[208:211], v[96:111]
  ds_read_b64_tr_b16 v[64:65], v4 offset:512
  ds_read_b64_tr_b16 v[66:67], v4 offset:640
  v_exp_f32 v217, v217
  v_exp_f32 v218, v218
  v_exp_f32 v219, v219
  v_exp_f32 v220, v220
  v_exp_f32 v221, v221
  v_exp_f32 v222, v222
  v_exp_f32 v223, v223
  v_cvt_pk_bf16_f32 v212, v216, v217
  v_cvt_pk_bf16_f32 v213, v218, v219
  v_cvt_pk_bf16_f32 v214, v220, v221
  v_cvt_pk_bf16_f32 v215, v222, v223
  v_exp_f32 v224, v224
  s_nop 0
  v_mfma_f32_32x32x16_bf16 v[96:111], v[68:71], v[212:215], v[96:111]
  ds_read_b64_tr_b16 v[68:69], v4 offset:768
  ds_read_b64_tr_b16 v[70:71], v4 offset:896
  v_exp_f32 v225, v225
  v_exp_f32 v226, v226
  s_waitcnt lgkmcnt(11)
  v_mfma_f32_32x32x16_bf16 v[208:223], v[80:83], v[40:43], 0
  v_exp_f32 v227, v227
  v_exp_f32 v228, v228
  v_exp_f32 v229, v229
  s_waitcnt lgkmcnt(10)
  v_mfma_f32_32x32x16_bf16 v[208:223], v[84:87], v[44:47], v[208:223]
  v_exp_f32 v230, v230
  v_exp_f32 v231, v231
  v_cvt_pk_bf16_f32 v224, v224, v225
  v_cvt_pk_bf16_f32 v225, v226, v227
  v_cvt_pk_bf16_f32 v226, v228, v229
  v_cvt_pk_bf16_f32 v227, v230, v231
  v_exp_f32 v232, v232
  s_nop 0
  v_mfma_f32_32x32x16_bf16 v[96:111], v[72:75], v[224:227], v[96:111]
  ds_read_b64_tr_b16 v[72:73], v4 offset:1024
  ds_read_b64_tr_b16 v[74:75], v4 offset:1152
  v_exp_f32 v233, v233
  v_exp_f32 v234, v234
  v_exp_f32 v235, v235
  v_exp_f32 v236, v236
  v_exp_f32 v237, v237
  v_exp_f32 v238, v238
  v_exp_f32 v239, v239
  v_cvt_pk_bf16_f32 v228, v232, v233
  v_cvt_pk_bf16_f32 v229, v234, v235
  v_cvt_pk_bf16_f32 v230, v236, v237
  v_cvt_pk_bf16_f32 v231, v238, v239
  v_cndmask_b32 v112, v240, v112, s[52:53]
  v_cndmask_b32 v113, v241, v113, s[54:55]
  v_mfma_f32_32x32x16_bf16 v[96:111], v[76:79], v[228:231], v[96:111]
  ds_read_b64_tr_b16 v[76:77], v4 offset:1280
  ds_read_b64_tr_b16 v[78:79], v4 offset:1408
  v_cndmask_b32 v114, v242, v114, s[56:57]
  v_cndmask_b32 v115, v243, v115, s[58:59]
  v_cndmask_b32 v116, v244, v116, s[60:61]
  v_cndmask_b32 v117, v245, v117, s[62:63]
  s_waitcnt lgkmcnt(9)
  v_mfma_f32_32x32x16_bf16 v[224:239], v[88:91], v[40:43], 0
  v_cndmask_b32 v118, v246, v118, s[64:65]
  v_cndmask_b32 v119, v247, v119, s[66:67]
  v_cndmask_b32 v120, v248, v120, s[68:69]
  v_cndmask_b32 v121, v249, v121, s[70:71]
  v_cndmask_b32 v122, v250, v122, s[72:73]
  v_cndmask_b32 v123, v251, v123, s[74:75]
  s_waitcnt lgkmcnt(8)
  v_mfma_f32_32x32x16_bf16 v[224:239], v[92:95], v[44:47], v[224:239]
  v_cndmask_b32 v124, v252, v124, s[76:77]
  v_cndmask_b32 v125, v253, v125, s[78:79]
  v_max_f32 v12, v112, v113
  v_max_f32 v13, v114, v115
  v_max_f32 v14, v116, v117
  v_cndmask_b32 v126, v254, v126, s[80:81]
  v_cndmask_b32 v127, v255, v127, s[82:83]
  v_max_f32 v15, v118, v119
  v_max3_f32 v12, v12, v120, v121
  v_max3_f32 v13, v13, v122, v123
  v_max3_f32 v14, v14, v124, v125
  v_max3_f32 v15, v15, v126, v127
  v_max3_f32 v12, v12, v128, v129
  v_max3_f32 v13, v13, v130, v131
  v_max3_f32 v14, v14, v132, v133
  v_max3_f32 v15, v15, v134, v135
  v_max3_f32 v12, v12, v136, v137
  v_max3_f32 v13, v13, v138, v139
  v_max3_f32 v14, v14, v140, v141
  v_max3_f32 v15, v15, v142, v143
  v_max3_f32 v12, v12, v144, v145
  v_max3_f32 v13, v13, v146, v147
  v_max3_f32 v14, v14, v148, v149
  v_max3_f32 v15, v15, v150, v151
  v_max3_f32 v12, v12, v152, v153
  v_max3_f32 v13, v13, v154, v155
  v_max3_f32 v14, v14, v156, v157
  v_max3_f32 v15, v15, v158, v159
  v_max3_f32 v12, v12, v160, v161
  v_max3_f32 v13, v13, v162, v163
  v_max3_f32 v14, v14, v164, v165
  v_max3_f32 v15, v15, v166, v167
  v_max3_f32 v12, v12, v168, v169
  v_max3_f32 v13, v13, v170, v171
  v_max3_f32 v14, v14, v172, v173
  v_max3_f32 v15, v15, v174, v175
  v_max3_f32 v12, v12, v176, v177
  v_max3_f32 v13, v13, v178, v179
  v_max3_f32 v14, v14, v180, v181
  v_max3_f32 v15, v15, v182, v183
  v_max3_f32 v12, v12, v184, v185
  v_mov_b32 v19, 155164
  v_mov_b32 v20, 1
  s_mov_b64 exec, 1
  ds_add_u32 v19, v20
  s_mov_b64 exec, -1
  s_nop 7
  s_nop 3
  v_max3_f32 v13, v13, v186, v187
  v_max3_f32 v14, v14, v188, v189
  v_max3_f32 v15, v15, v190, v191
  v_max3_f32 v12, v12, v192, v193
  v_max3_f32 v13, v13, v194, v195
  v_max3_f32 v14, v14, v196, v197
  v_max3_f32 v15, v15, v198, v199
  v_max3_f32 v12, v12, v200, v201
  v_max3_f32 v13, v13, v202, v203
  v_max3_f32 v14, v14, v204, v205
  v_max3_f32 v15, v15, v206, v207
  v_max3_f32 v12, v12, v208, v209
  v_max3_f32 v13, v13, v210, v211
  v_max3_f32 v14, v14, v212, v213
  v_max3_f32 v15, v15, v214, v215
  v_max3_f32 v12, v12, v216, v217
  v_max3_f32 v13, v13, v218, v219
  v_max3_f32 v14, v14, v220, v221
  v_max3_f32 v15, v15, v222, v223
  v_max3_f32 v12, v12, v224, v225
  v_max3_f32 v13, v13, v226, v227
  v_max3_f32 v14, v14, v228, v229
  v_max3_f32 v15, v15, v230, v231
  v_max3_f32 v12, v12, v232, v233
  v_max3_f32 v13, v13, v234, v235
  v_max3_f32 v14, v14, v236, v237
  v_max3_f32 v15, v15, v238, v239
  v_max3_f32 v12, v12, v13, v14
  v_max_f32 v12, v12, v15
  v_mov_b32 v13, v12
  v_rcp_f32 v18, v108
  s_nop 0
  v_permlane32_swap_b32 v12, v13
  v_max_f32 v12, v12, v13
  v_xor_b32 v12, 0x80000000, v12
  v_and_b32 v13, 0xffff0000, v12
  v_sub_f32 v12, v12, v13
  v_cvt_pk_bf16_f32 v32, v13, v12
  v_mul_f32 v96, v96, v18
  v_mul_f32 v97, v97, v18
  v_mfma_f32_32x32x16_bf16 v[112:127], v[36:39], v[32:35], v[112:127]
  v_mul_f32 v98, v98, v18
  v_mul_f32 v99, v99, v18
  v_cvt_pk_bf16_f32 v96, v96, v97
  v_mul_f32 v100, v100, v18
  v_mul_f32 v101, v101, v18
  v_cvt_pk_bf16_f32 v97, v98, v99
  v_mfma_f32_32x32x16_bf16 v[128:143], v[36:39], v[32:35], v[128:143]
  v_mul_f32 v102, v102, v18
  v_mul_f32 v103, v103, v18
  v_mul_f32 v104, v104, v18
  v_mul_f32 v105, v105, v18
  v_mul_f32 v106, v106, v18
  v_mul_f32 v107, v107, v18
  v_mfma_f32_32x32x16_bf16 v[144:159], v[36:39], v[32:35], v[144:159]
  v_exp_f32 v112, v112
  v_exp_f32 v113, v113
  v_exp_f32 v114, v114
  v_mfma_f32_32x32x16_bf16 v[160:175], v[36:39], v[32:35], v[160:175]
  v_exp_f32 v115, v115
  v_exp_f32 v116, v116
  v_exp_f32 v117, v117
  v_mfma_f32_32x32x16_bf16 v[176:191], v[36:39], v[32:35], v[176:191]
  v_exp_f32 v118, v118
  v_exp_f32 v119, v119
  v_exp_f32 v120, v120
  v_mfma_f32_32x32x16_bf16 v[192:207], v[36:39], v[32:35], v[192:207]
  v_exp_f32 v121, v121
  v_exp_f32 v122, v122
  v_exp_f32 v123, v123
  v_mfma_f32_32x32x16_bf16 v[208:223], v[36:39], v[32:35], v[208:223]
  v_cvt_pk_bf16_f32 v112, v112, v113
  v_cvt_pk_bf16_f32 v113, v114, v115
  v_cvt_pk_bf16_f32 v114, v116, v117
  v_cvt_pk_bf16_f32 v115, v118, v119
  v_cvt_pk_bf16_f32 v116, v120, v121
  v_cvt_pk_bf16_f32 v117, v122, v123
  v_mfma_f32_32x32x16_bf16 v[224:239], v[36:39], v[32:35], v[224:239]
  v_cvt_pk_bf16_f32 v98, v100, v101
  v_and_b32 v120, v112, v24
  v_and_b32 v121, v113, v25
  v_and_b32 v122, v114, v26
  v_and_b32 v123, v115, v27
  v_cvt_pk_bf16_f32 v99, v102, v103
  buffer_store_dwordx4 v[96:99], v9, s[28:31], s37 offen offset:0 sc1
  v_cvt_pk_bf16_f32 v100, v104, v105
  v_cvt_pk_bf16_f32 v101, v106, v107
  buffer_store_dwordx2 v[100:101], v10, s[28:31], s38 offen offset:0 sc1
  v_mfma_f32_32x32x16_bf16 v[96:111], v[56:59], v[120:123], 0
  ds_read_b64_tr_b16 v[56:57], v4 offset:1536
  ds_read_b64_tr_b16 v[58:59], v4 offset:1664
  v_exp_f32 v124, v124
  v_exp_f32 v125, v125
  v_exp_f32 v126, v126
  v_exp_f32 v127, v127
  v_cvt_pk_bf16_f32 v118, v124, v125
  v_cvt_pk_bf16_f32 v119, v126, v127
  v_and_b32 v124, v116, v28
  v_and_b32 v125, v117, v29
  v_and_b32 v126, v118, v30
  v_and_b32 v127, v119, v31
  v_xor_b32 v112, v112, v120
  v_xor_b32 v113, v113, v121
  v_mfma_f32_32x32x16_bf16 v[96:111], v[60:63], v[124:127], v[96:111]
  ds_read_b64_tr_b16 v[60:61], v4 offset:1792
  ds_read_b64_tr_b16 v[62:63], v4 offset:1920
  v_xor_b32 v114, v114, v122
  v_xor_b32 v115, v115, v123
  v_xor_b32 v116, v116, v124
  v_xor_b32 v117, v117, v125
  s_waitcnt lgkmcnt(11)
  v_mfma_f32_32x32x16_bf16 v[96:111], v[64:67], v[112:115], v[96:111]
  ds_read_b64_tr_b16 v[64:65], v4 offset:2048
  ds_read_b64_tr_b16 v[66:67], v4 offset:2176
  v_xor_b32 v118, v118, v126
  v_xor_b32 v119, v119, v127
  v_exp_f32 v128, v128
  s_waitcnt lgkmcnt(11)
  v_mfma_f32_32x32x16_bf16 v[96:111], v[68:71], v[116:119], v[96:111]
  ds_read_b64_tr_b16 v[68:69], v4 offset:2304
  ds_read_b64_tr_b16 v[70:71], v4 offset:2432
  v_exp_f32 v129, v129
  v_exp_f32 v130, v130
  v_exp_f32 v131, v131
  v_exp_f32 v132, v132
  v_exp_f32 v133, v133
  v_exp_f32 v134, v134
  v_exp_f32 v135, v135
  v_cvt_pk_bf16_f32 v128, v128, v129
  v_cvt_pk_bf16_f32 v129, v130, v131
  v_cvt_pk_bf16_f32 v130, v132, v133
  v_cvt_pk_bf16_f32 v131, v134, v135
  v_exp_f32 v136, v136
  s_waitcnt lgkmcnt(11)
  v_mfma_f32_32x32x16_bf16 v[96:111], v[72:75], v[128:131], v[96:111]
  ds_read_b64_tr_b16 v[72:73], v4 offset:2560
  ds_read_b64_tr_b16 v[74:75], v4 offset:2688
  v_exp_f32 v137, v137
  v_exp_f32 v138, v138
  v_exp_f32 v139, v139
  v_exp_f32 v140, v140
  v_exp_f32 v141, v141
  v_exp_f32 v142, v142
  v_exp_f32 v143, v143
  v_cvt_pk_bf16_f32 v132, v136, v137
  v_cvt_pk_bf16_f32 v133, v138, v139
  v_cvt_pk_bf16_f32 v134, v140, v141
  v_cvt_pk_bf16_f32 v135, v142, v143
  v_exp_f32 v144, v144
  s_waitcnt lgkmcnt(11)
  v_mfma_f32_32x32x16_bf16 v[96:111], v[76:79], v[132:135], v[96:111]
  ds_read_b64_tr_b16 v[76:77], v4 offset:2816
  ds_read_b64_tr_b16 v[78:79], v4 offset:2944
  v_exp_f32 v145, v145
  v_exp_f32 v146, v146
  v_exp_f32 v147, v147
  v_exp_f32 v148, v148
  v_exp_f32 v149, v149
  v_exp_f32 v150, v150
  v_exp_f32 v151, v151
  v_cvt_pk_bf16_f32 v144, v144, v145
  v_cvt_pk_bf16_f32 v145, v146, v147
  v_cvt_pk_bf16_f32 v146, v148, v149
  v_cvt_pk_bf16_f32 v147, v150, v151
  v_exp_f32 v152, v152
  s_waitcnt lgkmcnt(10)
  v_mfma_f32_32x32x16_bf16 v[96:111], v[56:59], v[144:147], v[96:111]
  ds_read_b64_tr_b16 v[56:57], v4 offset:3072
  ds_read_b64_tr_b16 v[58:59], v4 offset:3200
  v_exp_f32 v153, v153
  v_exp_f32 v154, v154
  v_exp_f32 v155, v155
  v_exp_f32 v156, v156
  v_exp_f32 v157, v157
  v_exp_f32 v158, v158
  v_exp_f32 v159, v159
  v_cvt_pk_bf16_f32 v148, v152, v153
  v_cvt_pk_bf16_f32 v149, v154, v155
  v_cvt_pk_bf16_f32 v150, v156, v157
  v_cvt_pk_bf16_f32 v151, v158, v159
  v_exp_f32 v160, v160
  s_waitcnt lgkmcnt(10)
  v_mfma_f32_32x32x16_bf16 v[96:111], v[60:63], v[148:151], v[96:111]
  ds_read_b64_tr_b16 v[60:61], v4 offset:3328
  ds_read_b64_tr_b16 v[62:63], v4 offset:3456
  v_exp_f32 v161, v161
  v_exp_f32 v162, v162
  v_exp_f32 v163, v163
  v_exp_f32 v164, v164
  v_exp_f32 v165, v165
  v_exp_f32 v166, v166
  v_exp_f32 v167, v167
  v_cvt_pk_bf16_f32 v160, v160, v161
  v_cvt_pk_bf16_f32 v161, v162, v163
  v_cvt_pk_bf16_f32 v162, v164, v165
  v_cvt_pk_bf16_f32 v163, v166, v167
  v_exp_f32 v168, v168
  s_waitcnt lgkmcnt(10)
  v_mfma_f32_32x32x16_bf16 v[96:111], v[64:67], v[160:163], v[96:111]
  ds_read_b64_tr_b16 v[64:65], v4 offset:3584
  ds_read_b64_tr_b16 v[66:67], v4 offset:3712
  v_exp_f32 v169, v169
  v_exp_f32 v170, v170
  v_exp_f32 v171, v171
  v_exp_f32 v172, v172
  v_exp_f32 v173, v173
  v_exp_f32 v174, v174
  v_exp_f32 v175, v175
  v_cvt_pk_bf16_f32 v164, v168, v169
  v_cvt_pk_bf16_f32 v165, v170, v171
  v_cvt_pk_bf16_f32 v166, v172, v173
  v_cvt_pk_bf16_f32 v167, v174, v175
  v_exp_f32 v176, v176
  s_waitcnt lgkmcnt(10)
  v_mfma_f32_32x32x16_bf16 v[96:111], v[68:71], v[164:167], v[96:111]
  ds_read_b64_tr_b16 v[68:69], v4 offset:3840
  ds_read_b64_tr_b16 v[70:71], v4 offset:3968
  v_exp_f32 v177, v177
  v_exp_f32 v178, v178
  v_exp_f32 v179, v179
  v_exp_f32 v180, v180
  v_exp_f32 v181, v181
  v_exp_f32 v182, v182
  v_exp_f32 v183, v183
  v_cvt_pk_bf16_f32 v176, v176, v177
  v_cvt_pk_bf16_f32 v177, v178, v179
  v_cvt_pk_bf16_f32 v178, v180, v181
  v_cvt_pk_bf16_f32 v179, v182, v183
  v_exp_f32 v184, v184
  s_waitcnt lgkmcnt(10)
  v_mfma_f32_32x32x16_bf16 v[96:111], v[72:75], v[176:179], v[96:111]
  ds_read_b64_tr_b16 v[72:73], v4 offset:4096
  ds_read_b64_tr_b16 v[74:75], v4 offset:4224
  v_exp_f32 v185, v185
  v_exp_f32 v186, v186
  v_exp_f32 v187, v187
  v_exp_f32 v188, v188
  v_exp_f32 v189, v189
  v_exp_f32 v190, v190
  v_exp_f32 v191, v191
  v_cvt_pk_bf16_f32 v180, v184, v185
  v_cvt_pk_bf16_f32 v181, v186, v187
  v_cvt_pk_bf16_f32 v182, v188, v189
  v_cvt_pk_bf16_f32 v183, v190, v191
  v_exp_f32 v192, v192
  s_waitcnt lgkmcnt(10)
  v_mfma_f32_32x32x16_bf16 v[96:111], v[76:79], v[180:183], v[96:111]
  ds_read_b64_tr_b16 v[76:77], v4 offset:4352
  ds_read_b64_tr_b16 v[78:79], v4 offset:4480
  v_exp_f32 v193, v193
  v_exp_f32 v194, v194
  v_exp_f32 v195, v195
  v_exp_f32 v196, v196
  v_exp_f32 v197, v197
  v_exp_f32 v198, v198
  v_exp_f32 v199, v199
  v_cvt_pk_bf16_f32 v192, v192, v193
  v_cvt_pk_bf16_f32 v193, v194, v195
  v_cvt_pk_bf16_f32 v194, v196, v197
  v_cvt_pk_bf16_f32 v195, v198, v199
  v_exp_f32 v200, v200
  s_waitcnt lgkmcnt(10)
  v_mfma_f32_32x32x16_bf16 v[96:111], v[56:59], v[192:195], v[96:111]
  v_exp_f32 v201, v201
  v_exp_f32 v202, v202
  v_exp_f32 v203, v203
  v_exp_f32 v204, v204
  v_exp_f32 v205, v205
  v_exp_f32 v206, v206
  v_exp_f32 v207, v207
  v_cvt_pk_bf16_f32 v196, v200, v201
  v_cvt_pk_bf16_f32 v197, v202, v203
  v_cvt_pk_bf16_f32 v198, v204, v205
  v_cvt_pk_bf16_f32 v199, v206, v207
  v_exp_f32 v208, v208
  s_waitcnt lgkmcnt(8)
  v_mfma_f32_32x32x16_bf16 v[96:111], v[60:63], v[196:199], v[96:111]
  v_exp_f32 v209, v209
  v_exp_f32 v210, v210
  v_exp_f32 v211, v211
  v_exp_f32 v212, v212
  v_exp_f32 v213, v213
  v_exp_f32 v214, v214
  v_exp_f32 v215, v215
  v_cvt_pk_bf16_f32 v208, v208, v209
  v_cvt_pk_bf16_f32 v209, v210, v211
  v_cvt_pk_bf16_f32 v210, v212, v213
  v_cvt_pk_bf16_f32 v211, v214, v215
  v_exp_f32 v216, v216
  s_waitcnt lgkmcnt(6)
  v_mfma_f32_32x32x16_bf16 v[96:111], v[64:67], v[208:211], v[96:111]
  v_exp_f32 v217, v217
  v_exp_f32 v218, v218
  v_exp_f32 v219, v219
  v_exp_f32 v220, v220
  v_exp_f32 v221, v221
  v_exp_f32 v222, v222
  v_exp_f32 v223, v223
  v_cvt_pk_bf16_f32 v212, v216, v217
  v_cvt_pk_bf16_f32 v213, v218, v219
  v_cvt_pk_bf16_f32 v214, v220, v221
  v_cvt_pk_bf16_f32 v215, v222, v223
  v_exp_f32 v224, v224
  s_waitcnt lgkmcnt(4)
  v_mfma_f32_32x32x16_bf16 v[96:111], v[68:71], v[212:215], v[96:111]
  v_exp_f32 v225, v225
  v_exp_f32 v226, v226
  v_exp_f32 v227, v227
  v_exp_f32 v228, v228
  v_exp_f32 v229, v229
  v_exp_f32 v230, v230
  v_exp_f32 v231, v231
  v_cvt_pk_bf16_f32 v224, v224, v225
  v_cvt_pk_bf16_f32 v225, v226, v227
  v_cvt_pk_bf16_f32 v226, v228, v229
  v_cvt_pk_bf16_f32 v227, v230, v231
  v_exp_f32 v232, v232
  s_waitcnt lgkmcnt(2)
  v_mfma_f32_32x32x16_bf16 v[96:111], v[72:75], v[224:227], v[96:111]
  v_exp_f32 v233, v233
  v_exp_f32 v234, v234
  v_exp_f32 v235, v235
  v_exp_f32 v236, v236
  v_exp_f32 v237, v237
  v_exp_f32 v238, v238
  v_exp_f32 v239, v239
  v_cvt_pk_bf16_f32 v228, v232, v233
  v_cvt_pk_bf16_f32 v229, v234, v235
  v_cvt_pk_bf16_f32 v230, v236, v237
  v_cvt_pk_bf16_f32 v231, v238, v239
  s_waitcnt lgkmcnt(0)
  s_nop 0
  v_mfma_f32_32x32x16_bf16 v[96:111], v[76:79], v[228:231], v[96:111]
  s_nop 11
  v_rcp_f32 v18, v108
  s_nop 0
  v_mul_f32 v96, v96, v18
  v_mul_f32 v97, v97, v18
  v_mul_f32 v98, v98, v18
  v_mul_f32 v99, v99, v18
  v_cvt_pk_bf16_f32 v96, v96, v97
  v_mul_f32 v100, v100, v18
  v_mul_f32 v101, v101, v18
  v_cvt_pk_bf16_f32 v97, v98, v99
  v_mul_f32 v102, v102, v18
  v_mul_f32 v103, v103, v18
  v_mul_f32 v104, v104, v18
  v_mul_f32 v105, v105, v18
  v_mul_f32 v106, v106, v18
  v_mul_f32 v107, v107, v18
  v_cvt_pk_bf16_f32 v98, v100, v101
  v_cvt_pk_bf16_f32 v99, v102, v103
  buffer_store_dwordx4 v[96:99], v9, s[28:31], s37 offen offset:512 sc1
  v_cvt_pk_bf16_f32 v100, v104, v105
  v_cvt_pk_bf16_f32 v101, v106, v107
  buffer_store_dwordx2 v[100:101], v10, s[28:31], s38 offen offset:256 sc1
  s_waitcnt vmcnt(0)
  s_mov_b64 exec, 1
  buffer_store_dword v23, v17, s[28:31], s39 offen sc1
  s_mov_b64 exec, -1
L_end:
  s_endpgm
L_code_end:
  .section .rodata,"a"
  .p2align 6
  .amdhsa_kernel parallel_sum__sliding_block__glu_gated_glu__prompt_kernel
  .amdhsa_next_free_vgpr 256
  .amdhsa_next_free_sgpr 102
  .amdhsa_accum_offset 256
  .amdhsa_group_segment_fixed_size 0
  .amdhsa_kernarg_size 80
  .amdhsa_user_sgpr_count 2
  .amdhsa_user_sgpr_kernarg_segment_ptr 1
  .amdhsa_system_sgpr_workgroup_id_x 1
  .end_amdhsa_kernel
```
